```python
import torch

def _softmax(x, axis=-1):
    return torch.softmax(x, dim=axis)
def _gelu(x):
    return torch.nn.functional.gelu(x, approximate="tanh")
def _silu(x):
    return torch.nn.functional.silu(x)
def _sigmoid(x):
    return torch.sigmoid(x)
def _layernorm(x, axis=-1, eps=1e-5):
    m = x.mean(dim=axis, keepdim=True)
    v = x.var(dim=axis, keepdim=True, unbiased=False)
    return (x - m) / torch.sqrt(v + eps)
def _scatter_add(tgt, idx, src, axis=0):
    return tgt.clone().index_add_(axis, idx, src)
def _segment_sum(src, seg, n):
    out = torch.zeros((n,) + src.shape[1:], dtype=src.dtype)
    return out.index_add_(0, seg, src)
def _pad(x, pw):
    flat = tuple(v for pair in reversed(pw) for v in pair)
    return torch.nn.functional.pad(x, flat)

kernel_name = 'gated_mix__mha_block_cached__mixer_channel_mlp__decode'

def setup_inputs():

    _w = (lambda a: (lambda t: t.to(torch.bfloat16) if t.is_floating_point() else t)(torch.as_tensor(a)))
    def _A_setup():
        B, Sq, D = 2, 1, 576
        H, Sk, Dh = 32, 4096, 128
        return {
            "x": _w((lambda *s: torch.randn(*s, dtype=torch.bfloat16) * 0.05)(B, Sq, D)),
            "k_cache": _w((lambda *s: torch.randn(*s, dtype=torch.bfloat16) * 6.4)(B, H, Sk, Dh)),
            "v_cache": _w((lambda *s: torch.randn(*s, dtype=torch.bfloat16) * 1.6)(B, H, Sk, Dh)),
            "wq": _w((lambda *s: torch.randn(*s, dtype=torch.bfloat16) * 6.4)(D, H * Dh) * (D ** -0.5)),
            "wo": _w((lambda *s: torch.randn(*s, dtype=torch.bfloat16) * 1.6)(H * Dh, D) * ((H * Dh) ** -0.5)),
        }
    _A_in = _A_setup()

    def _B_setup():
        B, S, D, F = 2, 1, 576, 4608
        return {
            "x": _w((lambda *s: torch.randn(*s, dtype=torch.bfloat16) * 0.05)(B, S, D)),
            "w1": _w((lambda *s: torch.randn(*s, dtype=torch.bfloat16) * 3.2)(D, F) * (D ** -0.5)),
            "b1": _w((lambda *s: torch.randn(*s, dtype=torch.bfloat16) * 1.6)(F)),
            "w2": _w((lambda *s: torch.randn(*s, dtype=torch.bfloat16) * 0.1)(F, D) * (F ** -0.5)),
            "b2": _w((lambda *s: torch.randn(*s, dtype=torch.bfloat16) * 0.1)(D)),
        }
    _B_in = _B_setup()

    return {
        "A_x": _A_in["x"],
        "A_k_cache": _A_in["k_cache"],
        "A_v_cache": _A_in["v_cache"],
        "A_wq": _A_in["wq"],
        "A_wo": _A_in["wo"],
        "B_x": _B_in["x"],
        "B_w1": _B_in["w1"],
        "B_b1": _B_in["b1"],
        "B_w2": _B_in["w2"],
        "B_b2": _B_in["b2"],
        "gate_w": _w((lambda *s: torch.randn(*s, dtype=torch.bfloat16) * 0.05)(576) * 16.0),
    }

def reference(A_x, A_k_cache, A_v_cache, A_wq, A_wo, B_x, B_w1, B_b1, B_w2, B_b2, gate_w):
    def _A_ref(x, k_cache, v_cache, wq, wo):
        B, Sq, D = x.shape
        H, Dh = 32, 128
        q = (lambda x, *d: x.permute(*d))((x @ wq).reshape(B, Sq, H, Dh), 0, 2, 1, 3)
        scores = torch.einsum("bhqd,bhkd->bhqk", q, k_cache) * (Dh ** -0.5)
        p = _softmax(scores, axis=-1)
        o = torch.einsum("bhqk,bhkd->bhqd", p, v_cache)
        return (lambda x, *d: x.permute(*d))(o, 0, 2, 1, 3).reshape(B, Sq, H * Dh) @ wo

    def _B_ref(x, w1, b1, w2, b2):
        y = _layernorm(x, axis=-1)
        h = _gelu(torch.einsum("bsd,df->bsf", y, w1) + b1)
        return torch.einsum("bsf,fd->bsd", h, w2) + b2

    x = A_x
    g = _sigmoid((x * gate_w).sum(-1, keepdims=True))
    a = _A_ref(x, A_k_cache, A_v_cache, A_wq, A_wo)
    b = _B_ref(x, B_w1, B_b1, B_w2, B_b2)
    return g * a + (1 - g) * b
```

```asm
; @launch grid=(256,1,1) block=(1024,1,1) lds=50944
.amdgcn_target "amdgcn-amd-amdhsa--gfx950"
.text
.globl gated_mix__mha_block_cached__mixer_channel_mlp__decode_kernel
.p2align 8
.type gated_mix__mha_block_cached__mixer_channel_mlp__decode_kernel,@function
gated_mix__mha_block_cached__mixer_channel_mlp__decode_kernel:
    s_load_dwordx16 s[4:19], s[0:1], 0
    s_load_dwordx8 s[20:27], s[0:1], 64
    s_load_dwordx4 s[28:31], s[0:1], 96
    s_cmp_ge_u32 s2, 256
    s_cbranch_scc1 L_end
    s_and_b32 s87, s2, 7
    s_bfe_u32 s3, s2, 0x40003
    s_lshl4_add_u32 s87, s87, s3
    s_and_b32 s3, s2, 0x80
    s_add_u32 s86, s87, s3
    s_lshl_b32 s3, s86, 18
    s_mov_b32 s34, 262144
    s_mov_b32 s35, 0x20000
    s_and_b32 s84, s2, 0x28
    s_mul_i32 s84, s84, 0x4040
    s_and_b32 s84, s84, 0x20800
    v_lshlrev_b32 v2, 4, v0
    v_lshrrev_b32 v1, 6, v0
    v_and_b32 v5, 63, v0
    v_and_b32 v3, 0x3f80, v0
    v_lshl_add_u32 v2, v3, 4, v2
    v_mad_u32_u24 v6, v1, 11, v5
    v_cmp_gt_u32 vcc, 11, v5
    v_mov_b32 v7, 0x4000
    v_readfirstlane_b32 s88, v1
    v_cndmask_b32 v6, v7, v6, vcc
    v_lshrrev_b32 v8, 3, v6
    v_lshlrev_b32 v8, 13, v8
    v_and_b32 v7, 7, v6
    v_lshl_add_u32 v8, v7, 7, v8
    s_lshr_b32 s96, s2, 3
    s_mul_i32 s96, s96, 147456
    s_and_b32 s97, s2, 7
    s_lshl_b32 s97, s97, 10
    s_add_u32 s96, s96, s97
    s_mov_b32 s74, 140288
    s_mov_b32 s75, 0x20000
    s_waitcnt lgkmcnt(0)
    s_add_u32 s32, s6, s3
    s_addc_u32 s33, s7, 0
    buffer_load_dwordx4 v[10:13], v2, s[32:35], s84 offen offset:0 nt
    s_add_u32 s72, s10, s96
    s_addc_u32 s73, s11, 0
    buffer_load_dword v7, v8, s[72:75], 0 offen
    s_xor_b32 s89, s84, 2048
    buffer_load_dwordx4 v[14:17], v2, s[32:35], s89 offen offset:0 nt
    s_add_u32 s36, s8, s3
    s_addc_u32 s37, s9, 0
    s_mov_b32 s38, 262144
    s_mov_b32 s39, 0x20000
    s_lshr_b32 s99, s87, 2
    s_lshr_b32 s85, s2, 7
    s_and_b32 s94, s87, 3
    s_lshl2_add_u32 s94, s85, s94
    s_lshl_b32 s95, s99, 8
    s_lshl_b32 s3, s85, 7
    s_add_u32 s3, s3, 655360
    s_load_dword s28, s[30:31], s3
    v_lshlrev_b32 v8, 4, v5
    v_lshlrev_b32 v9, 1, v5
    s_cmp_lg_u32 s88, 5
    s_cbranch_scc1 L_sw_1
    s_mul_i32 s3, s85, 1152
    s_add_u32 s56, s4, s3
    s_addc_u32 s57, s5, 0
    s_mov_b32 s58, 1152
    s_mov_b32 s59, 0x20000
    s_mov_b32 s64, s24
    s_mov_b32 s65, s25
    s_mov_b32 s66, 1152
    s_mov_b32 s67, 0x20000
    buffer_load_dwordx4 v[18:21], v8, s[56:59], 0 offen offset:0
    buffer_load_ushort v22, v9, s[56:59], 0 offen offset:1024
    buffer_load_dwordx4 v[24:27], v8, s[64:67], 0 offen offset:0
    buffer_load_ushort v23, v9, s[64:67], 0 offen offset:1024
L_sw_1:
    s_add_u32 s40, s10, s95
    s_addc_u32 s41, s11, 0
    s_mov_b32 s42, 4710656
    s_mov_b32 s43, 0x20000
    v_bfe_u32 v3, v0, 4, 2
    v_and_b32 v4, 15, v0
    v_mul_u32_u24 v30, 36, v1
    v_lshlrev_b32 v31, 4, v4
    v_lshl_add_u32 v28, v3, 3, v30
    v_add3_u32 v29, v30, v3, 32
    v_lshl_add_u32 v28, v28, 13, v31
    v_lshl_add_u32 v29, v29, 13, v31
    s_lshr_b32 s3, s2, 3
    s_mul_i32 s7, s3, 8192
    s_lshr_b32 s7, s7, 16
    s_mul_i32 s7, s7, 8
    s_sub_u32 s7, s3, s7
    s_mov_b32 s100, 0
    s_mul_i32 s3, s86, 2560
    s_add_u32 s60, s30, s3
    s_addc_u32 s61, s31, 0
    s_mov_b32 s62, 2320
    s_mov_b32 s63, 0x20000
    s_mul_i32 s3, s87, 72
    s_add_u32 s48, s16, s3
    s_addc_u32 s49, s17, 0
    s_mov_b32 s50, 5299272
    s_mov_b32 s51, 0x20000
    s_add_u32 s68, s18, s3
    s_addc_u32 s69, s19, 0
    s_mov_b32 s70, 72
    s_mov_b32 s71, 0x20000
    s_mul_i32 s3, s99, 147456
    s_add_u32 s44, s12, s3
    s_addc_u32 s45, s13, 0
    s_mov_b32 s46, 147456
    s_mov_b32 s47, 0x20000
    s_mul_i32 s3, s87, 41472
    s_add_u32 s52, s20, s3
    s_addc_u32 s53, s21, 0
    s_mov_b32 s54, 41472
    s_mov_b32 s55, 0x20000
    s_mov_b32 s76, s26
    s_mov_b32 s77, s27
    s_mov_b32 s78, 2304
    s_mov_b32 s79, 0x20000
    s_mov_b32 s80, s30
    s_mov_b32 s81, s31
    s_mov_b32 s82, 1246208
    s_mov_b32 s83, 0x20000
    s_mov_b32 s0, s16
    s_mov_b32 s1, s17
    s_mov_b32 s90, s22
    s_mov_b32 s91, s23
    s_lshr_b32 s3, s2, 3
    s_mul_i32 s92, s3, 10923
    s_lshr_b32 s92, s92, 16
    s_mul_i32 s92, s92, 6
    s_sub_u32 s92, s3, s92
    s_lshr_b32 s3, s2, 3
    s_mul_i32 s93, s3, 5958
    s_lshr_b32 s93, s93, 16
    s_mul_i32 s93, s93, 11
    s_sub_u32 s93, s3, s93
    s_barrier
    s_xor_b32 s89, s84, 32768
    buffer_load_dwordx4 v[32:35], v2, s[32:35], s89 offen offset:0 nt
    s_waitcnt vmcnt(3)
L_ry_2:
    s_xor_b32 s89, s84, 34816
    buffer_load_dwordx4 v[36:39], v2, s[32:35], s89 offen offset:0 nt
    s_cmp_lg_u32 s88, 5
    s_cbranch_scc1 L_wv_3
    s_nop 4
    s_waitcnt vmcnt(2)
    ds_write_b128 v8, v[18:21] offset:47104
    ds_write_b16 v9, v22 offset:48128
    v_lshlrev_b32 v40, 16, v18
    v_and_b32 v41, 0xffff0000, v18
    v_lshlrev_b32 v42, 16, v19
    v_and_b32 v43, 0xffff0000, v19
    v_lshlrev_b32 v44, 16, v20
    v_and_b32 v45, 0xffff0000, v20
    v_lshlrev_b32 v46, 16, v21
    v_and_b32 v47, 0xffff0000, v21
    v_lshlrev_b32 v48, 16, v22
    v_add_f32 v30, v40, v41
    v_add_f32 v30, v30, v42
    v_add_f32 v30, v30, v43
    v_add_f32 v30, v30, v44
    v_add_f32 v30, v30, v45
    v_add_f32 v30, v30, v46
    v_add_f32 v30, v30, v47
    v_add_f32 v30, v30, v48
    v_mov_b32 v51, 0x3f803f80
    v_lshlrev_b32 v50, 16, v23
    v_mul_f32 v50, v50, v48
    v_cvt_pk_bf16_f32 v50, 0, v50
    v_lshlrev_b32 v49, 16, v24
    v_and_b32 v52, 0xffff0000, v24
    v_mul_f32 v49, v49, v40
    v_mul_f32 v52, v52, v41
    v_cvt_pk_bf16_f32 v49, v49, v52
    v_dot2c_f32_bf16 v50, v49, v51
    v_lshlrev_b32 v49, 16, v25
    v_and_b32 v52, 0xffff0000, v25
    v_mul_f32 v49, v49, v42
    v_mul_f32 v52, v52, v43
    v_cvt_pk_bf16_f32 v49, v49, v52
    v_dot2c_f32_bf16 v50, v49, v51
    v_lshlrev_b32 v49, 16, v26
    v_and_b32 v52, 0xffff0000, v26
    v_mul_f32 v49, v49, v44
    v_mul_f32 v52, v52, v45
    v_cvt_pk_bf16_f32 v49, v49, v52
    v_dot2c_f32_bf16 v50, v49, v51
    v_lshlrev_b32 v49, 16, v27
    v_and_b32 v52, 0xffff0000, v27
    v_mul_f32 v49, v49, v46
    v_mul_f32 v52, v52, v47
    v_cvt_pk_bf16_f32 v49, v49, v52
    v_dot2c_f32_bf16 v50, v49, v51
    v_add_f32_dpp v30, v30, v30 row_ror:8 row_mask:0xf bank_mask:0xf
    s_nop 1
    v_add_f32_dpp v50, v50, v50 row_ror:8 row_mask:0xf bank_mask:0xf
    v_add_f32_dpp v30, v30, v30 row_ror:4 row_mask:0xf bank_mask:0xf
    s_nop 0
    v_add_f32_dpp v50, v50, v50 row_ror:4 row_mask:0xf bank_mask:0xf
    v_add_f32_dpp v30, v30, v30 row_ror:2 row_mask:0xf bank_mask:0xf
    s_nop 0
    v_add_f32_dpp v50, v50, v50 row_ror:2 row_mask:0xf bank_mask:0xf
    v_add_f32_dpp v30, v30, v30 row_ror:1 row_mask:0xf bank_mask:0xf
    s_nop 0
    v_add_f32_dpp v50, v50, v50 row_ror:1 row_mask:0xf bank_mask:0xf
    v_mov_b32 v53, v30
    v_mov_b32 v54, v50
    s_nop 0
    v_permlane16_swap_b32 v30, v53
    v_permlane16_swap_b32 v50, v54
    v_add_f32 v30, v30, v53
    v_add_f32 v50, v50, v54
    v_mov_b32 v53, v30
    v_mov_b32 v54, v50
    s_nop 0
    v_permlane32_swap_b32 v30, v53
    v_permlane32_swap_b32 v50, v54
    v_add_f32 v30, v30, v53
    v_add_f32 v50, v50, v54
L_wv_3:
    s_nop 4
    s_cmp_lg_u32 s7, 0
    s_cbranch_scc1 L_sk_4
    s_call_b64 s[24:25], L_sub_5
    s_branch L_sk_4
L_sub_5:
    s_barrier
    buffer_load_dwordx4 v[24:27], v28, s[40:43], 0 offen offset:0
    s_mov_b32 s89, 8192
    buffer_load_dwordx4 v[54:57], v28, s[40:43], s89 offen
    s_mov_b32 s89, 16384
    buffer_load_dwordx4 v[58:61], v28, s[40:43], s89 offen
    s_mov_b32 s89, 24576
    buffer_load_dwordx4 v[62:65], v28, s[40:43], s89 offen
    s_mov_b32 s89, 32768
    buffer_load_dwordx4 v[66:69], v28, s[40:43], s89 offen
    s_mov_b32 s89, 40960
    buffer_load_dwordx4 v[70:73], v28, s[40:43], s89 offen
    s_mov_b32 s89, 49152
    buffer_load_dwordx4 v[74:77], v28, s[40:43], s89 offen
    s_mov_b32 s89, 57344
    buffer_load_dwordx4 v[78:81], v28, s[40:43], s89 offen
    buffer_load_dwordx4 v[82:85], v29, s[40:43], 0 offen offset:0
    s_mov_b32 s100, 3
    s_barrier
    s_setpc_b64 s[24:25]
L_sk_4:
    s_cmp_eq_u32 s100, 0
    s_cbranch_scc1 L_rx_6
    s_sub_u32 s100, s100, 1
    s_waitcnt vmcnt(11)
    s_branch L_ry_7
L_rx_6:
    s_waitcnt vmcnt(2)
L_ry_7:
    s_barrier
    s_xor_b32 s89, s84, 65536
    buffer_load_dwordx4 v[86:89], v2, s[32:35], s89 offen offset:0 nt
    s_cmp_lg_u32 s88, 5
    s_cbranch_scc1 L_wv_8
    s_nop 4
    v_mul_f32 v30, 0x3ae38e39, v30
    v_sub_f32 v49, v40, v30
    v_mul_f32 v52, v49, v49
    v_sub_f32 v49, v41, v30
    v_fmac_f32 v52, v49, v49
    v_sub_f32 v49, v42, v30
    v_fmac_f32 v52, v49, v49
    v_sub_f32 v49, v43, v30
    v_fmac_f32 v52, v49, v49
    v_sub_f32 v49, v44, v30
    v_fmac_f32 v52, v49, v49
    v_sub_f32 v49, v45, v30
    v_fmac_f32 v52, v49, v49
    v_sub_f32 v49, v46, v30
    v_fmac_f32 v52, v49, v49
    v_sub_f32 v49, v47, v30
    v_fmac_f32 v52, v49, v49
    v_sub_f32 v49, v48, v30
    v_fmac_f32 v52, v49, v49
    v_cvt_pk_bf16_f32 v50, 0, v50
    v_mul_f32 v50, 0xbfb8aa3b, v50
    v_exp_f32 v50, v50
    v_add_f32_dpp v52, v52, v52 row_ror:8 row_mask:0xf bank_mask:0xf
    s_nop 1
    v_add_f32_dpp v52, v52, v52 row_ror:4 row_mask:0xf bank_mask:0xf
    s_nop 1
    v_add_f32_dpp v52, v52, v52 row_ror:2 row_mask:0xf bank_mask:0xf
    s_nop 1
    v_add_f32_dpp v52, v52, v52 row_ror:1 row_mask:0xf bank_mask:0xf
    v_add_f32 v50, 1.0, v50
    v_rcp_f32 v50, v50
    v_mov_b32 v23, v52
    s_nop 1
    v_permlane16_swap_b32 v52, v23
    v_add_f32 v52, v52, v23
    v_mov_b32 v23, v52
    s_nop 1
    v_permlane32_swap_b32 v52, v23
    v_add_f32 v52, v52, v23
    v_cvt_pk_bf16_f32 v50, 0, v50
    v_cvt_pk_bf16_f32 v30, 0, v30
    v_sub_f32 v51, 1.0, v50
    v_cvt_pk_bf16_f32 v51, 0, v51
    v_mov_b32 v49, 0
    ds_write_b64 v49, v[50:51] offset:9152
    ds_write_b16 v9, v49 offset:8960
    v_mul_f32 v52, 0x3ae38e39, v52
    v_cvt_pk_bf16_f32 v52, 0, v52
    v_add_f32 v52, 0x3727c5ac, v52
    v_cvt_pk_bf16_f32 v52, 0, v52
    v_sqrt_f32 v52, v52
    s_nop 0
    v_cvt_pk_bf16_f32 v52, 0, v52
    v_rcp_f32 v52, v52
L_wv_8:
    s_nop 4
    s_cmp_lg_u32 s7, 1
    s_cbranch_scc1 L_sk_9
    s_call_b64 s[24:25], L_sub_5
L_sk_9:
    s_cmp_eq_u32 s100, 0
    s_cbranch_scc1 L_rx_10
    s_sub_u32 s100, s100, 1
    s_waitcnt vmcnt(11)
    s_branch L_ry_11
L_rx_10:
    s_waitcnt vmcnt(2)
L_ry_11:
    s_xor_b32 s89, s84, 67584
    buffer_load_dwordx4 v[90:93], v2, s[32:35], s89 offen offset:0 nt
    s_cmp_lg_u32 s88, 5
    s_cbranch_scc1 L_wv_12
    s_nop 4
    v_sub_f32 v40, v40, v30
    v_sub_f32 v41, v41, v30
    v_sub_f32 v42, v42, v30
    v_sub_f32 v43, v43, v30
    v_sub_f32 v44, v44, v30
    v_sub_f32 v45, v45, v30
    v_sub_f32 v46, v46, v30
    v_sub_f32 v47, v47, v30
    v_sub_f32 v48, v48, v30
    v_cvt_pk_bf16_f32 v40, 0, v40
    v_cvt_pk_bf16_f32 v41, 0, v41
    v_cvt_pk_bf16_f32 v42, 0, v42
    v_cvt_pk_bf16_f32 v43, 0, v43
    v_cvt_pk_bf16_f32 v44, 0, v44
    v_cvt_pk_bf16_f32 v45, 0, v45
    v_cvt_pk_bf16_f32 v46, 0, v46
    v_cvt_pk_bf16_f32 v47, 0, v47
    v_cvt_pk_bf16_f32 v48, 0, v48
    v_mul_f32 v40, v40, v52
    v_mul_f32 v41, v41, v52
    v_mul_f32 v42, v42, v52
    v_mul_f32 v43, v43, v52
    v_mul_f32 v44, v44, v52
    v_mul_f32 v45, v45, v52
    v_mul_f32 v46, v46, v52
    v_mul_f32 v47, v47, v52
    v_mul_f32 v48, v48, v52
    v_cvt_pk_bf16_f32 v18, v40, v41
    v_cvt_pk_bf16_f32 v19, v42, v43
    v_cvt_pk_bf16_f32 v20, v44, v45
    v_cvt_pk_bf16_f32 v21, v46, v47
    v_cvt_pk_bf16_f32 v22, v48, v48
    ds_write_b128 v8, v[18:21] offset:48384
    ds_write_b16 v9, v22 offset:49408
    s_waitcnt lgkmcnt(0)
L_wv_12:
    s_nop 4
    s_cmp_lg_u32 s7, 2
    s_cbranch_scc1 L_sk_13
    s_call_b64 s[24:25], L_sub_5
L_sk_13:
    s_cmp_eq_u32 s100, 0
    s_cbranch_scc1 L_rx_14
    s_sub_u32 s100, s100, 1
    s_waitcnt vmcnt(11)
    s_branch L_ry_15
L_rx_14:
    s_waitcnt vmcnt(2)
L_ry_15:
    s_barrier
    s_xor_b32 s89, s84, 98304
    buffer_load_dwordx4 v[18:21], v2, s[32:35], s89 offen offset:0 nt
    v_mul_u32_u24 v9, 7282, v6
    v_lshrrev_b32 v9, 16, v9
    v_mul_u32_u24 v22, 9, v9
    v_sub_u32 v22, v6, v22
    v_mul_u32_u24 v9, 9216, v9
    v_lshl_add_u32 v9, v22, 7, v9
    s_lshr_b32 s3, s87, 4
    s_mul_i32 s3, s3, 1152
    s_and_b32 s89, s87, 15
    s_lshl4_add_u32 s89, s85, s89
    s_mul_i32 s89, s89, 165888
    s_add_u32 s3, s3, s89
    s_add_u32 s72, s0, s3
    s_addc_u32 s73, s1, 0
    s_mov_b32 s74, 157824
    s_mov_b32 s75, 0x20000
    buffer_load_dword v7, v9, s[72:75], 0 offen
    v_lshlrev_b32 v23, 3, v3
    v_mul_u32_u24 v9, 528, v1
    v_lshl_add_u32 v9, v4, 5, v9
    v_add_u32 v9, v9, v23
    v_mul_u32_u24 v22, 528, v4
    v_lshl_add_u32 v22, v1, 5, v22
    v_add_u32 v22, v22, v23
    v_lshrrev_b32 v30, 12, v28
    ds_read_b64 v[40:41], v30 offset:47104
    ds_read_b64 v[42:43], v30 offset:47112
    v_lshrrev_b32 v30, 12, v29
    ds_read_u16 v23, v30 offset:47104
    v_mov_b32 v30, 0
    ds_read_b64 v[44:45], v30 offset:9152
    s_waitcnt lgkmcnt(0)
    v_readfirstlane_b32 s96, v44
    v_readfirstlane_b32 s97, v45
    s_nop 1
    s_and_b32 s3, s97, 0x7fffffff
    s_cmp_eq_u32 s3, 0
    s_cselect_b32 s56, 1.0, s97
    s_cselect_b32 s57, 0, 1.0
    s_add_u32 s28, s28, 0x9e3779b1
    s_and_b32 s64, s28, 0xff
    s_bfe_u32 s65, s28, 0x80008
    s_bfe_u32 s66, s28, 0x80010
    s_bfe_u32 s67, s28, 0x80018
    s_cmp_lg_u32 s7, 3
    s_cbranch_scc1 L_sk_16
    s_call_b64 s[24:25], L_sub_5
L_sk_16:
    s_cmp_eq_u32 s100, 0
    s_cbranch_scc1 L_rx_17
    s_sub_u32 s100, s100, 1
    s_waitcnt vmcnt(12)
    s_branch L_ry_18
L_rx_17:
    s_waitcnt vmcnt(3)
L_ry_18:
    s_xor_b32 s89, s84, 100352
    buffer_load_dwordx4 v[44:47], v2, s[32:35], s89 offen offset:0 nt
    s_cmp_lg_u32 s7, 4
    s_cbranch_scc1 L_sk_19
    s_call_b64 s[24:25], L_sub_5
L_sk_19:
    s_cmp_eq_u32 s100, 0
    s_cbranch_scc1 L_rx_20
    s_sub_u32 s100, s100, 1
    s_waitcnt vmcnt(12)
    s_branch L_ry_21
L_rx_20:
    s_waitcnt vmcnt(3)
L_ry_21:
    s_barrier
    s_xor_b32 s89, s84, 131072
    buffer_load_dwordx4 v[48:51], v2, s[32:35], s89 offen offset:0 nt
    s_cmp_lg_u32 s7, 5
    s_cbranch_scc1 L_sk_22
    s_call_b64 s[24:25], L_sub_5
L_sk_22:
    s_cmp_eq_u32 s100, 0
    s_cbranch_scc1 L_rx_23
    s_sub_u32 s100, s100, 1
    s_waitcnt vmcnt(12)
    s_branch L_ry_24
L_rx_23:
    s_waitcnt vmcnt(3)
L_ry_24:
    s_xor_b32 s89, s84, 133120
    buffer_load_dwordx4 v[94:97], v2, s[32:35], s89 offen offset:0 nt
    s_cmp_lg_u32 s7, 6
    s_cbranch_scc1 L_sk_25
    s_call_b64 s[24:25], L_sub_5
L_sk_25:
    s_cmp_eq_u32 s100, 0
    s_cbranch_scc1 L_rx_26
    s_sub_u32 s100, s100, 1
    s_waitcnt vmcnt(11)
    s_branch L_ry_27
L_rx_26:
    s_waitcnt vmcnt(2)
L_ry_27:
    s_barrier
    s_xor_b32 s89, s84, 163840
    buffer_load_dwordx4 v[98:101], v2, s[32:35], s89 offen offset:0 nt
    s_cmp_lg_u32 s7, 7
    s_cbranch_scc1 L_sk_28
    s_call_b64 s[24:25], L_sub_5
L_sk_28:
    s_cmp_eq_u32 s100, 0
    s_cbranch_scc1 L_rx_29
    s_sub_u32 s100, s100, 1
    s_waitcnt vmcnt(11)
    s_branch L_ry_30
L_rx_29:
    s_waitcnt vmcnt(2)
L_ry_30:
    s_xor_b32 s89, s84, 165888
    buffer_load_dwordx4 v[102:105], v2, s[32:35], s89 offen offset:0 nt
    s_cmp_eq_u32 s100, 0
    s_cbranch_scc1 L_rx_31
    s_sub_u32 s100, s100, 1
    s_waitcnt vmcnt(11)
    s_branch L_ry_32
L_rx_31:
    s_waitcnt vmcnt(2)
L_ry_32:
    s_barrier
    s_xor_b32 s89, s84, 196608
    buffer_load_dwordx4 v[106:109], v2, s[32:35], s89 offen offset:0 nt
    s_waitcnt vmcnt(2)
    s_mov_b32 s98, 0x05040100
    s_mov_b32 s99, 0x07060302
    v_perm_b32 v28, v54, v24, s98
    v_perm_b32 v29, v54, v24, s99
    v_dot2_f32_bf16 v110, v28, v40, 0
    v_dot2_f32_bf16 v111, v29, v40, 0
    v_perm_b32 v28, v55, v25, s98
    v_perm_b32 v29, v55, v25, s99
    v_dot2_f32_bf16 v112, v28, v40, 0
    v_dot2_f32_bf16 v113, v29, v40, 0
    v_perm_b32 v28, v56, v26, s98
    v_perm_b32 v29, v56, v26, s99
    v_dot2_f32_bf16 v114, v28, v40, 0
    v_dot2_f32_bf16 v115, v29, v40, 0
    v_perm_b32 v28, v57, v27, s98
    v_perm_b32 v29, v57, v27, s99
    v_dot2_f32_bf16 v116, v28, v40, 0
    v_dot2_f32_bf16 v117, v29, v40, 0
    v_perm_b32 v28, v62, v58, s98
    v_perm_b32 v29, v62, v58, s99
    v_dot2c_f32_bf16 v110, v28, v41
    v_dot2c_f32_bf16 v111, v29, v41
    v_perm_b32 v28, v63, v59, s98
    v_perm_b32 v29, v63, v59, s99
    v_dot2c_f32_bf16 v112, v28, v41
    v_dot2c_f32_bf16 v113, v29, v41
    v_perm_b32 v28, v64, v60, s98
    v_perm_b32 v29, v64, v60, s99
    v_dot2c_f32_bf16 v114, v28, v41
    v_dot2c_f32_bf16 v115, v29, v41
    v_perm_b32 v28, v65, v61, s98
    v_perm_b32 v29, v65, v61, s99
    v_dot2c_f32_bf16 v116, v28, v41
    v_dot2c_f32_bf16 v117, v29, v41
    v_perm_b32 v28, v70, v66, s98
    v_perm_b32 v29, v70, v66, s99
    v_dot2c_f32_bf16 v110, v28, v42
    v_dot2c_f32_bf16 v111, v29, v42
    v_perm_b32 v28, v71, v67, s98
    v_perm_b32 v29, v71, v67, s99
    v_dot2c_f32_bf16 v112, v28, v42
    v_dot2c_f32_bf16 v113, v29, v42
    v_perm_b32 v28, v72, v68, s98
    v_perm_b32 v29, v72, v68, s99
    v_dot2c_f32_bf16 v114, v28, v42
    v_dot2c_f32_bf16 v115, v29, v42
    v_perm_b32 v28, v73, v69, s98
    v_perm_b32 v29, v73, v69, s99
    v_dot2c_f32_bf16 v116, v28, v42
    v_dot2c_f32_bf16 v117, v29, v42
    v_perm_b32 v28, v78, v74, s98
    v_perm_b32 v29, v78, v74, s99
    v_dot2c_f32_bf16 v110, v28, v43
    v_dot2c_f32_bf16 v111, v29, v43
    v_perm_b32 v28, v79, v75, s98
    v_perm_b32 v29, v79, v75, s99
    v_dot2c_f32_bf16 v112, v28, v43
    v_dot2c_f32_bf16 v113, v29, v43
    v_perm_b32 v28, v80, v76, s98
    v_perm_b32 v29, v80, v76, s99
    v_dot2c_f32_bf16 v114, v28, v43
    v_dot2c_f32_bf16 v115, v29, v43
    v_perm_b32 v28, v81, v77, s98
    v_perm_b32 v29, v81, v77, s99
    v_dot2c_f32_bf16 v116, v28, v43
    v_dot2c_f32_bf16 v117, v29, v43
    v_lshlrev_b32 v28, 16, v23
    v_dot2c_f32_bf16 v110, v82, v23
    v_dot2c_f32_bf16 v111, v82, v28
    v_dot2c_f32_bf16 v112, v83, v23
    v_dot2c_f32_bf16 v113, v83, v28
    v_dot2c_f32_bf16 v114, v84, v23
    v_dot2c_f32_bf16 v115, v84, v28
    v_dot2c_f32_bf16 v116, v85, v23
    v_dot2c_f32_bf16 v117, v85, v28
    v_permlane32_swap_b32 v110, v114
    v_permlane32_swap_b32 v111, v115
    v_permlane32_swap_b32 v112, v116
    v_permlane32_swap_b32 v113, v117
    v_add_f32 v110, v110, v114
    v_add_f32 v111, v111, v115
    v_add_f32 v112, v112, v116
    v_add_f32 v113, v113, v117
    s_nop 0
    v_permlane16_swap_b32 v110, v112
    v_permlane16_swap_b32 v111, v113
    v_add_f32 v110, v110, v112
    v_add_f32 v111, v111, v113
    ds_write_b64 v9, v[110:111] offset:0
    s_waitcnt lgkmcnt(0)
    s_sub_u32 s100, s100, 1
    s_max_i32 s100, s100, 0
    s_barrier
    s_xor_b32 s89, s84, 198656
    buffer_load_dwordx4 v[24:27], v2, s[32:35], s89 offen offset:0 nt
    v_lshlrev_b32 v23, 7, v6
    s_mul_i32 s3, s94, 18432
    s_add_u32 s72, s44, s3
    s_addc_u32 s73, s45, 0
    s_mov_b32 s74, 18432
    s_mov_b32 s75, 0x20000
    buffer_load_dword v7, v23, s[72:75], 0 offen
    ds_read_b64 v[28:29], v22 offset:0
    v_lshl_add_u32 v6, v1, 2, v3
    v_lshlrev_b32 v6, 2, v6
    s_waitcnt lgkmcnt(0)
    v_add_f32_dpp v28, v28, v28 row_ror:8 row_mask:0xf bank_mask:0xf
    v_add_f32_dpp v29, v29, v29 row_ror:8 row_mask:0xf bank_mask:0xf
    s_nop 0
    v_add_f32_dpp v28, v28, v28 row_ror:4 row_mask:0xf bank_mask:0xf
    v_add_f32_dpp v29, v29, v29 row_ror:4 row_mask:0xf bank_mask:0xf
    s_nop 0
    v_add_f32_dpp v28, v28, v28 row_ror:2 row_mask:0xf bank_mask:0xf
    v_add_f32_dpp v29, v29, v29 row_ror:2 row_mask:0xf bank_mask:0xf
    s_nop 0
    v_add_f32_dpp v28, v28, v28 row_ror:1 row_mask:0xf bank_mask:0xf
    v_add_f32_dpp v29, v29, v29 row_ror:1 row_mask:0xf bank_mask:0xf
    v_cvt_pk_bf16_f32 v28, v28, v29
    ds_write_b32 v6, v28 offset:8448
    s_waitcnt lgkmcnt(0)
    s_barrier
    ds_read_b128 v[40:43], v31 offset:8448
    s_mov_b32 s98, 0xcccccccc
    s_mov_b32 s99, 0xcccccccc
    s_mov_b32 vcc_lo, 0xaaaaaaaa
    s_mov_b32 vcc_hi, 0xaaaaaaaa
    s_waitcnt lgkmcnt(0)
    v_dot2_f32_bf16 v6, v10, v40, 0
    v_dot2_f32_bf16 v23, v14, v40, 0
    v_dot2_f32_bf16 v6, v11, v41, v6
    v_dot2_f32_bf16 v23, v15, v41, v23
    v_dot2_f32_bf16 v6, v12, v42, v6
    v_dot2_f32_bf16 v23, v16, v42, v23
    v_dot2_f32_bf16 v6, v13, v43, v6
    v_dot2_f32_bf16 v23, v17, v43, v23
    s_nop 1
    v_add_f32_dpp v6, v6, v6 row_ror:8 row_mask:0xf bank_mask:0x3
    s_nop 1
    v_add_f32_dpp v6, v23, v23 row_ror:8 row_mask:0xf bank_mask:0xc
    v_dot2_f32_bf16 v10, v32, v40, 0
    v_dot2_f32_bf16 v11, v36, v40, 0
    v_dot2_f32_bf16 v10, v33, v41, v10
    v_dot2_f32_bf16 v11, v37, v41, v11
    v_dot2_f32_bf16 v10, v34, v42, v10
    v_dot2_f32_bf16 v11, v38, v42, v11
    v_dot2_f32_bf16 v10, v35, v43, v10
    v_dot2_f32_bf16 v11, v39, v43, v11
    s_nop 1
    v_add_f32_dpp v10, v10, v10 row_ror:8 row_mask:0xf bank_mask:0x3
    s_nop 1
    v_add_f32_dpp v10, v11, v11 row_ror:8 row_mask:0xf bank_mask:0xc
    v_add_f32_dpp v6, v6, v6 row_shl:4 row_mask:0xf bank_mask:0x5
    s_nop 1
    v_add_f32_dpp v6, v10, v10 row_shr:4 row_mask:0xf bank_mask:0xa
    v_dot2_f32_bf16 v10, v86, v40, 0
    v_dot2_f32_bf16 v11, v90, v40, 0
    v_dot2_f32_bf16 v10, v87, v41, v10
    v_dot2_f32_bf16 v11, v91, v41, v11
    v_dot2_f32_bf16 v10, v88, v42, v10
    v_dot2_f32_bf16 v11, v92, v42, v11
    v_dot2_f32_bf16 v10, v89, v43, v10
    v_dot2_f32_bf16 v11, v93, v43, v11
    s_nop 1
    v_add_f32_dpp v10, v10, v10 row_ror:8 row_mask:0xf bank_mask:0x3
    s_nop 1
    v_add_f32_dpp v10, v11, v11 row_ror:8 row_mask:0xf bank_mask:0xc
    v_mul_u32_u24 v16, 43691, v0
    v_lshrrev_b32 v16, 18, v16
    v_mul_u32_u24 v15, 6, v16
    v_sub_u32 v15, v0, v15
    v_mul_u32_u24 v15, 12, v15
    v_mul_u32_u24 v11, 36864, v16
    v_add_u32 v11, v11, v15
    v_lshrrev_b32 v15, 4, v0
    v_lshlrev_b32 v15, 1, v15
    buffer_load_ushort v17, v15, s[68:71], 0 offen offset:0
    s_cmp_lg_u32 s92, 0
    s_cbranch_scc1 L_sk_33
    s_call_b64 s[24:25], L_sub_34
    s_branch L_sk_33
L_sub_34:
    s_barrier
    buffer_load_dwordx3 v[12:14], v11, s[48:51], 0 offen offset:0
    s_mov_b32 s89, 9216
    buffer_load_dwordx3 v[28:30], v11, s[48:51], s89 offen
    s_mov_b32 s89, 18432
    buffer_load_dwordx3 v[32:34], v11, s[48:51], s89 offen
    s_mov_b32 s89, 27648
    buffer_load_dwordx3 v[36:38], v11, s[48:51], s89 offen
    s_mov_b32 s100, 3
    s_barrier
    s_setpc_b64 s[24:25]
L_sk_33:
    s_cmp_eq_u32 s100, 0
    s_cbranch_scc1 L_rx_35
    s_sub_u32 s100, s100, 1
    s_waitcnt vmcnt(8)
    s_branch L_ry_36
L_rx_35:
    s_waitcnt vmcnt(4)
L_ry_36:
    s_barrier
    s_xor_b32 s89, s84, 229376
    buffer_load_dwordx4 v[52:55], v2, s[32:35], s89 offen offset:0 nt
    v_dot2_f32_bf16 v15, v18, v40, 0
    v_dot2_f32_bf16 v16, v44, v40, 0
    v_dot2_f32_bf16 v15, v19, v41, v15
    v_dot2_f32_bf16 v16, v45, v41, v16
    v_dot2_f32_bf16 v15, v20, v42, v15
    v_dot2_f32_bf16 v16, v46, v42, v16
    v_dot2_f32_bf16 v15, v21, v43, v15
    v_dot2_f32_bf16 v16, v47, v43, v16
    s_nop 1
    v_add_f32_dpp v15, v15, v15 row_ror:8 row_mask:0xf bank_mask:0x3
    s_nop 1
    v_add_f32_dpp v15, v16, v16 row_ror:8 row_mask:0xf bank_mask:0xc
    v_add_f32_dpp v10, v10, v10 row_shl:4 row_mask:0xf bank_mask:0x5
    s_nop 1
    v_add_f32_dpp v10, v15, v15 row_shr:4 row_mask:0xf bank_mask:0xa
    v_add_f32_dpp v6, v6, v6 quad_perm:[2,3,0,1] row_mask:0xf bank_mask:0xf
    s_nop 0
    v_add_f32_dpp v10, v10, v10 quad_perm:[2,3,0,1] row_mask:0xf bank_mask:0xf
    v_cndmask_b32 v6, v6, v10, s[98:99]
    v_dot2_f32_bf16 v10, v48, v40, 0
    v_dot2_f32_bf16 v15, v94, v40, 0
    v_dot2_f32_bf16 v10, v49, v41, v10
    v_dot2_f32_bf16 v15, v95, v41, v15
    v_dot2_f32_bf16 v10, v50, v42, v10
    v_dot2_f32_bf16 v15, v96, v42, v15
    v_dot2_f32_bf16 v10, v51, v43, v10
    v_dot2_f32_bf16 v15, v97, v43, v15
    s_nop 1
    v_add_f32_dpp v10, v10, v10 row_ror:8 row_mask:0xf bank_mask:0x3
    s_nop 1
    v_add_f32_dpp v10, v15, v15 row_ror:8 row_mask:0xf bank_mask:0xc
    v_dot2_f32_bf16 v15, v98, v40, 0
    v_dot2_f32_bf16 v16, v102, v40, 0
    v_dot2_f32_bf16 v15, v99, v41, v15
    v_dot2_f32_bf16 v16, v103, v41, v16
    v_dot2_f32_bf16 v15, v100, v42, v15
    v_dot2_f32_bf16 v16, v104, v42, v16
    v_dot2_f32_bf16 v15, v101, v43, v15
    v_dot2_f32_bf16 v16, v105, v43, v16
    s_nop 1
    v_add_f32_dpp v15, v15, v15 row_ror:8 row_mask:0xf bank_mask:0x3
    s_nop 1
    v_add_f32_dpp v15, v16, v16 row_ror:8 row_mask:0xf bank_mask:0xc
    v_add_f32_dpp v10, v10, v10 row_shl:4 row_mask:0xf bank_mask:0x5
    s_nop 1
    v_add_f32_dpp v10, v15, v15 row_shr:4 row_mask:0xf bank_mask:0xa
    s_cmp_lg_u32 s92, 1
    s_cbranch_scc1 L_sk_37
    s_call_b64 s[24:25], L_sub_34
L_sk_37:
    s_cmp_eq_u32 s100, 0
    s_cbranch_scc1 L_rx_38
    s_sub_u32 s100, s100, 1
    s_waitcnt vmcnt(8)
    s_branch L_ry_39
L_rx_38:
    s_waitcnt vmcnt(4)
L_ry_39:
    s_xor_b32 s89, s84, 231424
    buffer_load_dwordx4 v[18:21], v2, s[32:35], s89 offen offset:0 nt
    v_dot2_f32_bf16 v15, v106, v40, 0
    v_dot2_f32_bf16 v15, v107, v41, v15
    v_dot2_f32_bf16 v15, v108, v42, v15
    v_dot2_f32_bf16 v15, v109, v43, v15
    s_cmp_lg_u32 s92, 2
    s_cbranch_scc1 L_sk_40
    s_call_b64 s[24:25], L_sub_34
L_sk_40:
    s_cmp_eq_u32 s100, 0
    s_cbranch_scc1 L_rx_41
    s_sub_u32 s100, s100, 1
    s_waitcnt vmcnt(8)
    s_branch L_ry_42
L_rx_41:
    s_waitcnt vmcnt(4)
L_ry_42:
    s_barrier
    buffer_load_dwordx4 v[44:47], v2, s[36:39], s84 offen offset:0 nt
    v_dot2_f32_bf16 v16, v24, v40, 0
    v_dot2_f32_bf16 v16, v25, v41, v16
    v_dot2_f32_bf16 v16, v26, v42, v16
    v_dot2_f32_bf16 v16, v27, v43, v16
    v_add_f32_dpp v15, v15, v15 row_ror:8 row_mask:0xf bank_mask:0x3
    s_nop 1
    v_add_f32_dpp v15, v16, v16 row_ror:8 row_mask:0xf bank_mask:0xc
    s_cmp_lg_u32 s92, 3
    s_cbranch_scc1 L_sk_43
    s_call_b64 s[24:25], L_sub_34
L_sk_43:
    s_cmp_eq_u32 s100, 0
    s_cbranch_scc1 L_rx_44
    s_sub_u32 s100, s100, 1
    s_waitcnt vmcnt(6)
    s_branch L_ry_45
L_rx_44:
    s_waitcnt vmcnt(2)
L_ry_45:
    s_xor_b32 s89, s84, 2048
    buffer_load_dwordx4 v[24:27], v2, s[36:39], s89 offen offset:0 nt
    v_dot2_f32_bf16 v16, v52, v40, 0
    v_dot2_f32_bf16 v16, v53, v41, v16
    v_dot2_f32_bf16 v16, v54, v42, v16
    v_dot2_f32_bf16 v16, v55, v43, v16
    s_cmp_lg_u32 s92, 4
    s_cbranch_scc1 L_sk_46
    s_call_b64 s[24:25], L_sub_34
L_sk_46:
    s_cmp_eq_u32 s100, 0
    s_cbranch_scc1 L_rx_47
    s_sub_u32 s100, s100, 1
    s_waitcnt vmcnt(6)
    s_branch L_ry_48
L_rx_47:
    s_waitcnt vmcnt(2)
L_ry_48:
    s_barrier
    s_xor_b32 s89, s84, 32768
    buffer_load_dwordx4 v[48:51], v2, s[36:39], s89 offen offset:0 nt
    v_dot2_f32_bf16 v23, v18, v40, 0
    v_dot2_f32_bf16 v23, v19, v41, v23
    v_dot2_f32_bf16 v23, v20, v42, v23
    v_dot2_f32_bf16 v23, v21, v43, v23
    v_add_f32_dpp v16, v16, v16 row_ror:8 row_mask:0xf bank_mask:0x3
    s_nop 1
    v_add_f32_dpp v16, v23, v23 row_ror:8 row_mask:0xf bank_mask:0xc
    v_add_f32_dpp v15, v15, v15 row_shl:4 row_mask:0xf bank_mask:0x5
    s_nop 1
    v_add_f32_dpp v15, v16, v16 row_shr:4 row_mask:0xf bank_mask:0xa
    v_add_f32_dpp v10, v10, v10 quad_perm:[2,3,0,1] row_mask:0xf bank_mask:0xf
    s_nop 0
    v_add_f32_dpp v15, v15, v15 quad_perm:[2,3,0,1] row_mask:0xf bank_mask:0xf
    v_cndmask_b32 v10, v10, v15, s[98:99]
    v_add_f32_dpp v6, v6, v6 quad_perm:[1,0,3,2] row_mask:0xf bank_mask:0xf
    s_nop 0
    v_add_f32_dpp v10, v10, v10 quad_perm:[1,0,3,2] row_mask:0xf bank_mask:0xf
    v_cndmask_b32 v6, v6, v10, vcc
    v_cvt_pk_bf16_f32 v6, 0, v6
    v_mul_f32 v6, 0x3db504f3, v6
    v_cvt_pk_bf16_f32 v6, 0, v6
    v_mov_b32 v18, v6
    s_nop 1
    v_max_f32_dpp v18, v18, v18 row_ror:8 row_mask:0xf bank_mask:0xf
    s_nop 1
    v_max_f32_dpp v18, v18, v18 row_ror:4 row_mask:0xf bank_mask:0xf
    s_nop 1
    v_max_f32_dpp v18, v18, v18 row_ror:2 row_mask:0xf bank_mask:0xf
    s_nop 1
    v_max_f32_dpp v18, v18, v18 row_ror:1 row_mask:0xf bank_mask:0xf
    v_sub_f32 v6, v6, v18
    v_mul_f32 v6, 0x3fb8aa3b, v6
    v_exp_f32 v6, v6
    v_lshrrev_b32 v10, 4, v0
    v_lshlrev_b32 v10, 3, v10
    v_cvt_pk_bf16_f32 v15, v6, 0
    v_cvt_pk_bf16_f32 v16, 0, v6
    v_mov_b32 v19, v16
    s_nop 1
    v_add_f32_dpp v19, v19, v19 row_ror:8 row_mask:0xf bank_mask:0xf
    s_nop 1
    v_add_f32_dpp v19, v19, v19 row_ror:4 row_mask:0xf bank_mask:0xf
    s_nop 1
    v_add_f32_dpp v19, v19, v19 row_ror:2 row_mask:0xf bank_mask:0xf
    s_nop 1
    v_add_f32_dpp v19, v19, v19 row_ror:1 row_mask:0xf bank_mask:0xf
    ds_write_b64 v10, v[18:19] offset:49920
    v_mov_b32 v52, 0
    v_mov_b32 v53, 0
    v_mov_b32 v54, 0
    v_mov_b32 v55, 0
    v_mov_b32 v56, 0
    v_mov_b32 v57, 0
    v_mov_b32 v58, 0
    v_mov_b32 v59, 0
    s_waitcnt lgkmcnt(0)
    s_cmp_lg_u32 s92, 5
    s_cbranch_scc1 L_sk_49
    s_call_b64 s[24:25], L_sub_34
L_sk_49:
    s_cmp_eq_u32 s100, 0
    s_cbranch_scc1 L_rx_50
    s_sub_u32 s100, s100, 1
    s_waitcnt vmcnt(6)
    s_branch L_ry_51
L_rx_50:
    s_waitcnt vmcnt(2)
L_ry_51:
    s_barrier
    s_xor_b32 s89, s84, 34816
    buffer_load_dwordx4 v[18:21], v2, s[36:39], s89 offen offset:0 nt
    s_cmp_lg_u32 s88, 0
    s_cbranch_scc1 L_wv_52
    s_nop 4
    v_lshlrev_b32 v10, 3, v5
    ds_read_b64 v[40:41], v10 offset:49920
    s_waitcnt lgkmcnt(0)
    v_mov_b32 v42, v40
    s_nop 1
    v_max_f32_dpp v42, v42, v42 row_ror:8 row_mask:0xf bank_mask:0xf
    s_nop 1
    v_max_f32_dpp v42, v42, v42 row_ror:4 row_mask:0xf bank_mask:0xf
    s_nop 1
    v_max_f32_dpp v42, v42, v42 row_ror:2 row_mask:0xf bank_mask:0xf
    s_nop 1
    v_max_f32_dpp v42, v42, v42 row_ror:1 row_mask:0xf bank_mask:0xf
    v_mov_b32 v23, v42
    s_nop 1
    v_permlane16_swap_b32 v42, v23
    v_max_f32 v42, v42, v23
    v_mov_b32 v23, v42
    s_nop 1
    v_permlane32_swap_b32 v42, v23
    v_max_f32 v42, v42, v23
    v_sub_f32 v10, v40, v42
    v_mul_f32 v10, 0x3fb8aa3b, v10
    v_exp_f32 v10, v10
    s_nop 0
    v_mul_f32 v43, v10, v41
    s_nop 1
    v_add_f32_dpp v43, v43, v43 row_ror:8 row_mask:0xf bank_mask:0xf
    s_nop 1
    v_add_f32_dpp v43, v43, v43 row_ror:4 row_mask:0xf bank_mask:0xf
    s_nop 1
    v_add_f32_dpp v43, v43, v43 row_ror:2 row_mask:0xf bank_mask:0xf
    s_nop 1
    v_add_f32_dpp v43, v43, v43 row_ror:1 row_mask:0xf bank_mask:0xf
    v_mov_b32 v23, v43
    s_nop 1
    v_permlane16_swap_b32 v43, v23
    v_add_f32 v43, v43, v23
    v_mov_b32 v23, v43
    s_nop 1
    v_permlane32_swap_b32 v43, v23
    v_add_f32 v43, v43, v23
    v_mov_b32 v60, v42
    v_mov_b32 v61, s28
    v_mov_b32 v62, v43
    v_mov_b32 v63, s28
    s_mov_b64 exec, 1
    buffer_store_dwordx4 v[60:63], v1, s[60:63], 0 offen offset:2304 sc1
    s_mov_b64 exec, -1
L_wv_52:
    s_nop 4
    v_dot2c_f32_bf16_dpp v52, v15, v44 row_newbcast:0 row_mask:0xf bank_mask:0xf
    v_dot2c_f32_bf16_dpp v53, v16, v44 row_newbcast:0 row_mask:0xf bank_mask:0xf
    v_dot2c_f32_bf16_dpp v54, v15, v45 row_newbcast:0 row_mask:0xf bank_mask:0xf
    v_dot2c_f32_bf16_dpp v55, v16, v45 row_newbcast:0 row_mask:0xf bank_mask:0xf
    v_dot2c_f32_bf16_dpp v56, v15, v46 row_newbcast:0 row_mask:0xf bank_mask:0xf
    v_dot2c_f32_bf16_dpp v57, v16, v46 row_newbcast:0 row_mask:0xf bank_mask:0xf
    v_dot2c_f32_bf16_dpp v58, v15, v47 row_newbcast:0 row_mask:0xf bank_mask:0xf
    v_dot2c_f32_bf16_dpp v59, v16, v47 row_newbcast:0 row_mask:0xf bank_mask:0xf
    v_mul_u32_u24 v95, 9216, v1
    v_add_u32 v94, v95, v8
    v_lshl_add_u32 v95, v5, 1, v95
    v_add_u32 v95, 1024, v95
    s_cmp_lg_u32 s93, 5
    s_cbranch_scc1 L_sk_53
    s_call_b64 s[24:25], L_sub_54
    s_branch L_sk_53
L_sub_54:
    s_barrier
    s_mov_b32 s89, 4608
    buffer_load_dwordx4 v[42:45], v94, s[44:47], 0 offen offset:0
    buffer_load_ushort v23, v95, s[44:47], 0 offen offset:0
    buffer_load_dwordx4 v[64:67], v94, s[44:47], 0 offen offset:1152
    buffer_load_ushort v31, v95, s[44:47], 0 offen offset:1152
    buffer_load_dwordx4 v[68:71], v94, s[44:47], 0 offen offset:2304
    buffer_load_ushort v35, v95, s[44:47], 0 offen offset:2304
    buffer_load_dwordx4 v[72:75], v94, s[44:47], 0 offen offset:3456
    buffer_load_ushort v39, v95, s[44:47], 0 offen offset:3456
    buffer_load_dwordx4 v[76:79], v94, s[44:47], s89 offen offset:0
    buffer_load_ushort v46, v95, s[44:47], s89 offen offset:0
    buffer_load_dwordx4 v[80:83], v94, s[44:47], s89 offen offset:1152
    buffer_load_ushort v47, v95, s[44:47], s89 offen offset:1152
    buffer_load_dwordx4 v[84:87], v94, s[44:47], s89 offen offset:2304
    buffer_load_ushort v92, v95, s[44:47], s89 offen offset:2304
    buffer_load_dwordx4 v[88:91], v94, s[44:47], s89 offen offset:3456
    buffer_load_ushort v93, v95, s[44:47], s89 offen offset:3456
    s_mov_b32 s100, 3
    s_barrier
    s_setpc_b64 s[24:25]
L_sk_53:
    s_cmp_eq_u32 s100, 0
    s_cbranch_scc1 L_rx_55
    s_sub_u32 s100, s100, 1
    s_waitcnt vmcnt(6)
    s_branch L_ry_56
L_rx_55:
    s_waitcnt vmcnt(2)
L_ry_56:
    s_barrier
    s_xor_b32 s89, s84, 65536
    buffer_load_dwordx4 v[96:99], v2, s[36:39], s89 offen offset:0 nt
    v_dot2c_f32_bf16_dpp v52, v15, v24 row_newbcast:8 row_mask:0xf bank_mask:0xf
    v_dot2c_f32_bf16_dpp v53, v16, v24 row_newbcast:8 row_mask:0xf bank_mask:0xf
    v_dot2c_f32_bf16_dpp v54, v15, v25 row_newbcast:8 row_mask:0xf bank_mask:0xf
    v_dot2c_f32_bf16_dpp v55, v16, v25 row_newbcast:8 row_mask:0xf bank_mask:0xf
    v_dot2c_f32_bf16_dpp v56, v15, v26 row_newbcast:8 row_mask:0xf bank_mask:0xf
    v_dot2c_f32_bf16_dpp v57, v16, v26 row_newbcast:8 row_mask:0xf bank_mask:0xf
    v_dot2c_f32_bf16_dpp v58, v15, v27 row_newbcast:8 row_mask:0xf bank_mask:0xf
    v_dot2c_f32_bf16_dpp v59, v16, v27 row_newbcast:8 row_mask:0xf bank_mask:0xf
    v_mul_u32_u24 v26, 43691, v0
    v_lshrrev_b32 v26, 18, v26
    v_lshlrev_b32 v26, 3, v26
    ds_read_b64 v[24:25], v26 offset:48384
    s_waitcnt vmcnt(2)
    s_mov_b32 s98, 0x05040100
    s_mov_b32 s99, 0x07060302
    s_waitcnt lgkmcnt(0)
    v_perm_b32 v26, v28, v12, s98
    v_perm_b32 v27, v28, v12, s99
    v_dot2_f32_bf16 v100, v26, v24, 0
    v_dot2_f32_bf16 v101, v27, v24, 0
    v_perm_b32 v26, v29, v13, s98
    v_perm_b32 v27, v29, v13, s99
    v_dot2_f32_bf16 v102, v26, v24, 0
    v_dot2_f32_bf16 v103, v27, v24, 0
    v_perm_b32 v26, v30, v14, s98
    v_perm_b32 v27, v30, v14, s99
    v_dot2_f32_bf16 v104, v26, v24, 0
    v_dot2_f32_bf16 v105, v27, v24, 0
    v_perm_b32 v26, v36, v32, s98
    v_perm_b32 v27, v36, v32, s99
    v_dot2_f32_bf16 v100, v26, v25, v100
    v_dot2_f32_bf16 v101, v27, v25, v101
    v_perm_b32 v26, v37, v33, s98
    v_perm_b32 v27, v37, v33, s99
    v_dot2_f32_bf16 v102, v26, v25, v102
    v_dot2_f32_bf16 v103, v27, v25, v103
    v_perm_b32 v26, v38, v34, s98
    v_perm_b32 v27, v38, v34, s99
    v_dot2_f32_bf16 v104, v26, v25, v104
    v_dot2_f32_bf16 v105, v27, v25, v105
    v_mul_u32_u24 v26, 24, v0
    ds_write_b64 v26, v[100:101] offset:9216
    ds_write_b64 v26, v[102:103] offset:9224
    ds_write_b64 v26, v[104:105] offset:9232
    s_waitcnt lgkmcnt(0)
    s_cmp_lg_u32 s93, 6
    s_cbranch_scc1 L_sk_57
    s_call_b64 s[24:25], L_sub_54
L_sk_57:
    s_sub_u32 s100, s100, 1
    s_max_i32 s100, s100, 0
    s_barrier
    s_xor_b32 s89, s84, 67584
    buffer_load_dwordx4 v[24:27], v2, s[36:39], s89 offen offset:0 nt
    v_dot2c_f32_bf16_dpp v52, v15, v48 row_newbcast:4 row_mask:0xf bank_mask:0xf
    v_dot2c_f32_bf16_dpp v53, v16, v48 row_newbcast:4 row_mask:0xf bank_mask:0xf
    v_dot2c_f32_bf16_dpp v54, v15, v49 row_newbcast:4 row_mask:0xf bank_mask:0xf
    v_dot2c_f32_bf16_dpp v55, v16, v49 row_newbcast:4 row_mask:0xf bank_mask:0xf
    v_dot2c_f32_bf16_dpp v56, v15, v50 row_newbcast:4 row_mask:0xf bank_mask:0xf
    v_dot2c_f32_bf16_dpp v57, v16, v50 row_newbcast:4 row_mask:0xf bank_mask:0xf
    v_dot2c_f32_bf16_dpp v58, v15, v51 row_newbcast:4 row_mask:0xf bank_mask:0xf
    v_dot2c_f32_bf16_dpp v59, v16, v51 row_newbcast:4 row_mask:0xf bank_mask:0xf
    s_cmp_gt_u32 s88, 8
    s_cbranch_scc1 L_hs_58
    v_lshrrev_b32 v12, 4, v0
    v_mul_u32_u24 v11, 1296, v4
    v_lshl_add_u32 v11, v12, 2, v11
    v_add_u32 v11, 9216, v11
    ds_read2_b32 v[100:101], v11 offset0:0 offset1:36
    ds_read2_b32 v[102:103], v11 offset0:72 offset1:108
    ds_read2_b32 v[104:105], v11 offset0:144 offset1:180
    ds_read2_b32 v[106:107], v11 offset0:216 offset1:252
    ds_read_b32 v108, v11 offset:1152
    v_and_b32 v11, 15, v12
    v_lshlrev_b32 v11, 2, v11
    v_bfe_u32 v109, v12, 4, 1
    v_lshl_add_u32 v11, v109, 1, v11
    v_lshrrev_b32 v12, 5, v12
    v_lshl_add_u32 v12, v12, 6, v11
    s_waitcnt lgkmcnt(0)
    v_add_f32 v100, v100, v104
    v_add_f32 v101, v101, v105
    v_add_f32 v102, v102, v106
    v_add_f32 v103, v103, v107
    v_add_f32 v100, v100, v108
    v_add_f32 v101, v101, v102
    v_add_f32 v100, v100, v103
    v_add_f32 v100, v100, v101
    s_nop 1
    v_add_f32_dpp v100, v100, v100 row_ror:8 row_mask:0xf bank_mask:0xf
    s_nop 1
    v_add_f32_dpp v100, v100, v100 row_ror:4 row_mask:0xf bank_mask:0xf
    s_nop 1
    v_add_f32_dpp v100, v100, v100 row_ror:2 row_mask:0xf bank_mask:0xf
    s_nop 1
    v_add_f32_dpp v100, v100, v100 row_ror:1 row_mask:0xf bank_mask:0xf
    v_cvt_pk_bf16_f32 v100, 0, v100
    v_lshlrev_b32 v17, 16, v17
    v_add_f32 v100, v100, v17
    v_cvt_pk_bf16_f32 v100, 0, v100
    v_mul_f32 v101, v100, v100
    v_mov_b32 v102, 0xc0135761
    v_fmac_f32 v102, 0xbdd2d3e8, v101
    v_mul_f32 v102, v102, v100
    v_exp_f32 v102, v102
    s_nop 0
    v_add_f32 v102, 1.0, v102
    v_rcp_f32 v102, v102
    s_nop 0
    v_mul_f32 v100, v100, v102
    v_cvt_pk_bf16_f32 v100, 0, v100
    v_mul_f32 v100, s57, v100
    v_cvt_pk_bf16_f32 v100, v100, 0
    ds_write_b16 v12, v100 offset:8960
    s_waitcnt lgkmcnt(0)
L_hs_58:
    s_nop 2
    s_cmp_lg_u32 s93, 7
    s_cbranch_scc1 L_sk_59
    s_call_b64 s[24:25], L_sub_54
L_sk_59:
    s_cmp_eq_u32 s100, 0
    s_cbranch_scc1 L_rx_60
    s_sub_u32 s100, s100, 1
    s_waitcnt vmcnt(18)
    s_branch L_ry_61
L_rx_60:
    s_waitcnt vmcnt(2)
L_ry_61:
    s_barrier
    s_xor_b32 s89, s84, 98304
    buffer_load_dwordx4 v[48:51], v2, s[36:39], s89 offen offset:0 nt
    v_dot2c_f32_bf16_dpp v52, v15, v18 row_newbcast:12 row_mask:0xf bank_mask:0xf
    v_dot2c_f32_bf16_dpp v53, v16, v18 row_newbcast:12 row_mask:0xf bank_mask:0xf
    v_dot2c_f32_bf16_dpp v54, v15, v19 row_newbcast:12 row_mask:0xf bank_mask:0xf
    v_dot2c_f32_bf16_dpp v55, v16, v19 row_newbcast:12 row_mask:0xf bank_mask:0xf
    v_dot2c_f32_bf16_dpp v56, v15, v20 row_newbcast:12 row_mask:0xf bank_mask:0xf
    v_dot2c_f32_bf16_dpp v57, v16, v20 row_newbcast:12 row_mask:0xf bank_mask:0xf
    v_dot2c_f32_bf16_dpp v58, v15, v21 row_newbcast:12 row_mask:0xf bank_mask:0xf
    v_dot2c_f32_bf16_dpp v59, v16, v21 row_newbcast:12 row_mask:0xf bank_mask:0xf
    v_lshlrev_b32 v11, 2, v1
    v_add_u32 v11, 8960, v11
    ds_read2_b32 v[12:13], v11 offset0:0 offset1:16
    v_mul_u32_u24 v17, 1152, v1
    v_add_u32 v14, v17, v8
    v_lshl_add_u32 v17, v5, 1, v17
    s_waitcnt lgkmcnt(0)
    v_readfirstlane_b32 s4, v12
    v_readfirstlane_b32 s5, v13
    s_cmp_lg_u32 s93, 8
    s_cbranch_scc1 L_sk_62
    s_call_b64 s[24:25], L_sub_54
L_sk_62:
    s_cmp_eq_u32 s100, 0
    s_cbranch_scc1 L_rx_63
    s_sub_u32 s100, s100, 1
    s_waitcnt vmcnt(18)
    s_branch L_ry_64
L_rx_63:
    s_waitcnt vmcnt(2)
L_ry_64:
    s_xor_b32 s89, s84, 100352
    buffer_load_dwordx4 v[18:21], v2, s[36:39], s89 offen offset:0 nt
    v_dot2c_f32_bf16_dpp v52, v15, v96 row_newbcast:2 row_mask:0xf bank_mask:0xf
    v_dot2c_f32_bf16_dpp v53, v16, v96 row_newbcast:2 row_mask:0xf bank_mask:0xf
    v_dot2c_f32_bf16_dpp v54, v15, v97 row_newbcast:2 row_mask:0xf bank_mask:0xf
    v_dot2c_f32_bf16_dpp v55, v16, v97 row_newbcast:2 row_mask:0xf bank_mask:0xf
    v_dot2c_f32_bf16_dpp v56, v15, v98 row_newbcast:2 row_mask:0xf bank_mask:0xf
    v_dot2c_f32_bf16_dpp v57, v16, v98 row_newbcast:2 row_mask:0xf bank_mask:0xf
    v_dot2c_f32_bf16_dpp v58, v15, v99 row_newbcast:2 row_mask:0xf bank_mask:0xf
    v_dot2c_f32_bf16_dpp v59, v16, v99 row_newbcast:2 row_mask:0xf bank_mask:0xf
    s_cmp_lg_u32 s93, 9
    s_cbranch_scc1 L_sk_65
    s_call_b64 s[24:25], L_sub_54
L_sk_65:
    s_cmp_eq_u32 s100, 0
    s_cbranch_scc1 L_rx_66
    s_sub_u32 s100, s100, 1
    s_waitcnt vmcnt(18)
    s_branch L_ry_67
L_rx_66:
    s_waitcnt vmcnt(2)
L_ry_67:
    s_barrier
    s_xor_b32 s89, s84, 131072
    buffer_load_dwordx4 v[96:99], v2, s[36:39], s89 offen offset:0 nt
    v_dot2c_f32_bf16_dpp v52, v15, v24 row_newbcast:10 row_mask:0xf bank_mask:0xf
    v_dot2c_f32_bf16_dpp v53, v16, v24 row_newbcast:10 row_mask:0xf bank_mask:0xf
    v_dot2c_f32_bf16_dpp v54, v15, v25 row_newbcast:10 row_mask:0xf bank_mask:0xf
    v_dot2c_f32_bf16_dpp v55, v16, v25 row_newbcast:10 row_mask:0xf bank_mask:0xf
    v_dot2c_f32_bf16_dpp v56, v15, v26 row_newbcast:10 row_mask:0xf bank_mask:0xf
    v_dot2c_f32_bf16_dpp v57, v16, v26 row_newbcast:10 row_mask:0xf bank_mask:0xf
    v_dot2c_f32_bf16_dpp v58, v15, v27 row_newbcast:10 row_mask:0xf bank_mask:0xf
    v_dot2c_f32_bf16_dpp v59, v16, v27 row_newbcast:10 row_mask:0xf bank_mask:0xf
    s_cmp_lg_u32 s93, 10
    s_cbranch_scc1 L_sk_68
    s_call_b64 s[24:25], L_sub_54
L_sk_68:
    s_cmp_eq_u32 s100, 0
    s_cbranch_scc1 L_rx_69
    s_sub_u32 s100, s100, 1
    s_waitcnt vmcnt(18)
    s_branch L_ry_70
L_rx_69:
    s_waitcnt vmcnt(2)
L_ry_70:
    s_xor_b32 s89, s84, 133120
    buffer_load_dwordx4 v[24:27], v2, s[36:39], s89 offen offset:0 nt
    v_dot2c_f32_bf16_dpp v52, v15, v48 row_newbcast:6 row_mask:0xf bank_mask:0xf
    v_dot2c_f32_bf16_dpp v53, v16, v48 row_newbcast:6 row_mask:0xf bank_mask:0xf
    v_dot2c_f32_bf16_dpp v54, v15, v49 row_newbcast:6 row_mask:0xf bank_mask:0xf
    v_dot2c_f32_bf16_dpp v55, v16, v49 row_newbcast:6 row_mask:0xf bank_mask:0xf
    v_dot2c_f32_bf16_dpp v56, v15, v50 row_newbcast:6 row_mask:0xf bank_mask:0xf
    v_dot2c_f32_bf16_dpp v57, v16, v50 row_newbcast:6 row_mask:0xf bank_mask:0xf
    v_dot2c_f32_bf16_dpp v58, v15, v51 row_newbcast:6 row_mask:0xf bank_mask:0xf
    v_dot2c_f32_bf16_dpp v59, v16, v51 row_newbcast:6 row_mask:0xf bank_mask:0xf
    v_mov_b32 v10, 0
    s_cmp_lg_u32 s88, 0
    s_cbranch_scc1 L_wv_71
    s_nop 4
    s_and_b32 s3, s86, 0xfffffffc
    s_mul_i32 s3, s3, 2560
    v_and_b32 v10, 3, v0
    v_mul_u32_u24 v10, 2560, v10
    v_add_u32 v10, s3, v10
    buffer_load_dwordx4 v[60:63], v10, s[80:83], 0 offen offset:2304 sc1
L_wv_71:
    s_nop 4
    s_cmp_lg_u32 s93, 0
    s_cbranch_scc1 L_sk_72
    s_call_b64 s[24:25], L_sub_54
L_sk_72:
    s_cmp_eq_u32 s100, 0
    s_cbranch_scc1 L_rx_73
    s_sub_u32 s100, s100, 1
    s_waitcnt vmcnt(18)
    s_branch L_ry_74
L_rx_73:
    s_waitcnt vmcnt(2)
L_ry_74:
    s_barrier
    s_xor_b32 s89, s84, 163840
    buffer_load_dwordx4 v[48:51], v2, s[36:39], s89 offen offset:0 nt
    v_dot2c_f32_bf16_dpp v52, v15, v18 row_newbcast:14 row_mask:0xf bank_mask:0xf
    v_dot2c_f32_bf16_dpp v53, v16, v18 row_newbcast:14 row_mask:0xf bank_mask:0xf
    v_dot2c_f32_bf16_dpp v54, v15, v19 row_newbcast:14 row_mask:0xf bank_mask:0xf
    v_dot2c_f32_bf16_dpp v55, v16, v19 row_newbcast:14 row_mask:0xf bank_mask:0xf
    v_dot2c_f32_bf16_dpp v56, v15, v20 row_newbcast:14 row_mask:0xf bank_mask:0xf
    v_dot2c_f32_bf16_dpp v57, v16, v20 row_newbcast:14 row_mask:0xf bank_mask:0xf
    v_dot2c_f32_bf16_dpp v58, v15, v21 row_newbcast:14 row_mask:0xf bank_mask:0xf
    v_dot2c_f32_bf16_dpp v59, v16, v21 row_newbcast:14 row_mask:0xf bank_mask:0xf
    v_mul_u32_u24 v12, 2368, v1
    v_add_u32 v11, v12, v8
    v_lshl_add_u32 v12, v5, 2, v12
    v_and_b32 v19, 3, v0
    v_mul_u32_u24 v13, 2368, v19
    v_lshrrev_b32 v18, 2, v0
    v_lshlrev_b32 v18, 4, v18
    v_add_u32 v13, v13, v18
    v_lshl_add_u32 v18, v19, 12, v18
    s_mov_b32 s72, s90
    s_mov_b32 s73, s91
    s_mov_b32 s74, 1152
    s_mov_b32 s75, 0x20000
    v_and_b32 v19, 3, v0
    v_mul_u32_u24 v22, 528, v19
    v_lshl_add_u32 v22, v1, 5, v22
    v_bfe_u32 v19, v0, 2, 2
    v_lshl_add_u32 v22, v19, 3, v22
    v_mov_b32 v21, 0
    v_mov_b32 v19, 0
    s_and_b32 s3, s2, 127
    s_cmp_ge_u32 s3, 18
    s_cbranch_scc1 L_nc_75
    s_mul_i32 s7, s85, 327680
    s_lshl_b32 s89, s3, 7
    s_add_u32 s7, s7, s89
    v_lshrrev_b32 v19, 3, v0
    v_mul_u32_u24 v19, 2560, v19
    v_and_b32 v20, 7, v0
    v_lshl_add_u32 v19, v20, 4, v19
    s_lshl_b32 s89, s3, 5
    v_and_b32 v29, 31, v0
    v_add_u32 v21, s89, v29
    s_cmp_ge_u32 s3, 16
    s_cbranch_scc1 L_colB_76
    v_bfe_u32 v30, v21, 2, 6
    v_lshlrev_b32 v30, 3, v30
    v_lshrrev_b32 v28, 8, v21
    v_lshl_add_u32 v30, v28, 2, v30
    v_and_b32 v21, 3, v21
    v_add_u32 v21, v21, v30
L_colB_76:
    v_lshlrev_b32 v21, 1, v21
    s_cmp_lg_u32 s88, 0
    s_cbranch_scc1 L_b2_77
    buffer_load_ushort v28, v21, s[72:75], 0 offen
L_b2_77:
    v_lshlrev_b32 v20, 4, v20
    v_lshl_add_u32 v20, v3, 2, v20
    v_lshl_add_u32 v20, v1, 7, v20
    v_lshrrev_b32 v30, 5, v0
    v_lshlrev_b32 v30, 10, v30
    v_lshl_add_u32 v29, v29, 2, v30
L_nc_75:
    v_mov_b32 v30, 0xffffff00
    s_cmp_lg_u32 s93, 1
    s_cbranch_scc1 L_sk_78
    s_call_b64 s[24:25], L_sub_54
L_sk_78:
    s_cmp_eq_u32 s100, 0
    s_cbranch_scc1 L_rx_79
    s_sub_u32 s100, s100, 1
    s_waitcnt vmcnt(18)
    s_branch L_ry_80
L_rx_79:
    s_waitcnt vmcnt(2)
L_ry_80:
    s_xor_b32 s89, s84, 165888
    buffer_load_dwordx4 v[100:103], v2, s[36:39], s89 offen offset:0 nt
    v_dot2c_f32_bf16_dpp v52, v15, v96 row_newbcast:1 row_mask:0xf bank_mask:0xf
    v_dot2c_f32_bf16_dpp v53, v16, v96 row_newbcast:1 row_mask:0xf bank_mask:0xf
    v_dot2c_f32_bf16_dpp v54, v15, v97 row_newbcast:1 row_mask:0xf bank_mask:0xf
    v_dot2c_f32_bf16_dpp v55, v16, v97 row_newbcast:1 row_mask:0xf bank_mask:0xf
    v_dot2c_f32_bf16_dpp v56, v15, v98 row_newbcast:1 row_mask:0xf bank_mask:0xf
    v_dot2c_f32_bf16_dpp v57, v16, v98 row_newbcast:1 row_mask:0xf bank_mask:0xf
    v_dot2c_f32_bf16_dpp v58, v15, v99 row_newbcast:1 row_mask:0xf bank_mask:0xf
    v_dot2c_f32_bf16_dpp v59, v16, v99 row_newbcast:1 row_mask:0xf bank_mask:0xf
    s_cmp_lg_u32 s93, 2
    s_cbranch_scc1 L_sk_81
    s_call_b64 s[24:25], L_sub_54
L_sk_81:
    s_cmp_eq_u32 s100, 0
    s_cbranch_scc1 L_rx_82
    s_sub_u32 s100, s100, 1
    s_waitcnt vmcnt(18)
    s_branch L_ry_83
L_rx_82:
    s_waitcnt vmcnt(2)
L_ry_83:
    s_barrier
    s_xor_b32 s89, s84, 196608
    buffer_load_dwordx4 v[96:99], v2, s[36:39], s89 offen offset:0 nt
    v_dot2c_f32_bf16_dpp v52, v15, v24 row_newbcast:9 row_mask:0xf bank_mask:0xf
    v_dot2c_f32_bf16_dpp v53, v16, v24 row_newbcast:9 row_mask:0xf bank_mask:0xf
    v_dot2c_f32_bf16_dpp v54, v15, v25 row_newbcast:9 row_mask:0xf bank_mask:0xf
    v_dot2c_f32_bf16_dpp v55, v16, v25 row_newbcast:9 row_mask:0xf bank_mask:0xf
    v_dot2c_f32_bf16_dpp v56, v15, v26 row_newbcast:9 row_mask:0xf bank_mask:0xf
    v_dot2c_f32_bf16_dpp v57, v16, v26 row_newbcast:9 row_mask:0xf bank_mask:0xf
    v_dot2c_f32_bf16_dpp v58, v15, v27 row_newbcast:9 row_mask:0xf bank_mask:0xf
    v_dot2c_f32_bf16_dpp v59, v16, v27 row_newbcast:9 row_mask:0xf bank_mask:0xf
    s_cmp_lg_u32 s93, 3
    s_cbranch_scc1 L_sk_84
    s_call_b64 s[24:25], L_sub_54
L_sk_84:
    s_cmp_eq_u32 s100, 0
    s_cbranch_scc1 L_rx_85
    s_sub_u32 s100, s100, 1
    s_waitcnt vmcnt(18)
    s_branch L_ry_86
L_rx_85:
    s_waitcnt vmcnt(2)
L_ry_86:
    s_xor_b32 s89, s84, 198656
    buffer_load_dwordx4 v[24:27], v2, s[36:39], s89 offen offset:0 nt
    v_dot2c_f32_bf16_dpp v52, v15, v48 row_newbcast:5 row_mask:0xf bank_mask:0xf
    v_dot2c_f32_bf16_dpp v53, v16, v48 row_newbcast:5 row_mask:0xf bank_mask:0xf
    v_dot2c_f32_bf16_dpp v54, v15, v49 row_newbcast:5 row_mask:0xf bank_mask:0xf
    v_dot2c_f32_bf16_dpp v55, v16, v49 row_newbcast:5 row_mask:0xf bank_mask:0xf
    v_dot2c_f32_bf16_dpp v56, v15, v50 row_newbcast:5 row_mask:0xf bank_mask:0xf
    v_dot2c_f32_bf16_dpp v57, v16, v50 row_newbcast:5 row_mask:0xf bank_mask:0xf
    v_dot2c_f32_bf16_dpp v58, v15, v51 row_newbcast:5 row_mask:0xf bank_mask:0xf
    v_dot2c_f32_bf16_dpp v59, v16, v51 row_newbcast:5 row_mask:0xf bank_mask:0xf
    s_cmp_lg_u32 s88, 0
    s_cbranch_scc1 L_wv_87
    s_nop 4
    s_mov_b32 s6, 200000
L_pm_88:
    s_nop 0
    v_cmp_ne_u32 vcc, s28, v61
    v_cmp_ne_u32 s[98:99], s28, v63
    s_nop 1
    s_or_b64 vcc, vcc, s[98:99]
    s_cbranch_scc0 L_pmok_89
    s_sub_u32 s6, s6, 1
    s_cbranch_scc1 L_pmok_89
    buffer_load_dwordx4 v[60:63], v10, s[80:83], 0 offen offset:2304 sc1
    s_waitcnt vmcnt(0)
    s_branch L_pm_88
L_pmok_89:
    s_nop 4
    v_mov_b32 v32, v60
    s_nop 1
    v_max_f32_dpp v32, v32, v32 quad_perm:[1,0,3,2] row_mask:0xf bank_mask:0xf
    s_nop 1
    v_max_f32_dpp v32, v32, v32 quad_perm:[2,3,0,1] row_mask:0xf bank_mask:0xf
    v_sub_f32 v33, v60, v32
    v_mul_f32 v33, 0x3fb8aa3b, v33
    v_exp_f32 v33, v33
    v_sub_f32 v40, v40, v32
    v_mul_f32 v40, 0x3fb8aa3b, v40
    v_exp_f32 v40, v40
    v_mul_f32 v33, v33, v62
    s_nop 1
    v_add_f32_dpp v33, v33, v33 quad_perm:[1,0,3,2] row_mask:0xf bank_mask:0xf
    s_nop 1
    v_add_f32_dpp v33, v33, v33 quad_perm:[2,3,0,1] row_mask:0xf bank_mask:0xf
    v_mul_f32 v33, s56, v33
    v_rcp_f32 v33, v33
    v_mul_f32 v40, s96, v40
    v_mul_f32 v40, v40, v33
    v_lshlrev_b32 v33, 2, v5
    ds_write_b32 v33, v40 offset:8704
    s_waitcnt lgkmcnt(0)
L_wv_87:
    s_nop 4
    s_cmp_lg_u32 s93, 4
    s_cbranch_scc1 L_sk_90
    s_call_b64 s[24:25], L_sub_54
L_sk_90:
    s_cmp_eq_u32 s100, 0
    s_cbranch_scc1 L_rx_91
    s_sub_u32 s100, s100, 1
    s_waitcnt vmcnt(18)
    s_branch L_ry_92
L_rx_91:
    s_waitcnt vmcnt(2)
L_ry_92:
    s_barrier
    s_xor_b32 s89, s84, 229376
    buffer_load_dwordx4 v[48:51], v2, s[36:39], s89 offen offset:0 nt
    v_dot2c_f32_bf16_dpp v52, v15, v100 row_newbcast:13 row_mask:0xf bank_mask:0xf
    v_dot2c_f32_bf16_dpp v53, v16, v100 row_newbcast:13 row_mask:0xf bank_mask:0xf
    v_dot2c_f32_bf16_dpp v54, v15, v101 row_newbcast:13 row_mask:0xf bank_mask:0xf
    v_dot2c_f32_bf16_dpp v55, v16, v101 row_newbcast:13 row_mask:0xf bank_mask:0xf
    v_dot2c_f32_bf16_dpp v56, v15, v102 row_newbcast:13 row_mask:0xf bank_mask:0xf
    v_dot2c_f32_bf16_dpp v57, v16, v102 row_newbcast:13 row_mask:0xf bank_mask:0xf
    v_dot2c_f32_bf16_dpp v58, v15, v103 row_newbcast:13 row_mask:0xf bank_mask:0xf
    v_dot2c_f32_bf16_dpp v59, v16, v103 row_newbcast:13 row_mask:0xf bank_mask:0xf
    v_lshrrev_b32 v32, 4, v0
    v_lshlrev_b32 v32, 2, v32
    ds_read_b32 v10, v32 offset:8704
    s_waitcnt lgkmcnt(0)
    v_mul_f32 v6, v6, v10
    v_mul_f32 v52, v52, v10
    v_mul_f32 v53, v53, v10
    v_mul_f32 v54, v54, v10
    v_mul_f32 v55, v55, v10
    v_mul_f32 v56, v56, v10
    v_mul_f32 v57, v57, v10
    v_mul_f32 v58, v58, v10
    v_mul_f32 v59, v59, v10
    v_cvt_pk_bf16_f32 v15, v6, 0
    v_cvt_pk_bf16_f32 v16, 0, v6
    s_cmp_eq_u32 s100, 0
    s_cbranch_scc1 L_rx_93
    s_sub_u32 s100, s100, 1
    s_waitcnt vmcnt(18)
    s_branch L_ry_94
L_rx_93:
    s_waitcnt vmcnt(2)
L_ry_94:
    s_xor_b32 s89, s84, 231424
    buffer_load_dwordx4 v[60:63], v2, s[36:39], s89 offen offset:0 nt
    v_dot2c_f32_bf16_dpp v52, v15, v96 row_newbcast:3 row_mask:0xf bank_mask:0xf
    v_dot2c_f32_bf16_dpp v53, v16, v96 row_newbcast:3 row_mask:0xf bank_mask:0xf
    v_dot2c_f32_bf16_dpp v54, v15, v97 row_newbcast:3 row_mask:0xf bank_mask:0xf
    v_dot2c_f32_bf16_dpp v55, v16, v97 row_newbcast:3 row_mask:0xf bank_mask:0xf
    v_dot2c_f32_bf16_dpp v56, v15, v98 row_newbcast:3 row_mask:0xf bank_mask:0xf
    v_dot2c_f32_bf16_dpp v57, v16, v98 row_newbcast:3 row_mask:0xf bank_mask:0xf
    v_dot2c_f32_bf16_dpp v58, v15, v99 row_newbcast:3 row_mask:0xf bank_mask:0xf
    v_dot2c_f32_bf16_dpp v59, v16, v99 row_newbcast:3 row_mask:0xf bank_mask:0xf
    s_waitcnt vmcnt(2)
    s_mov_b32 s98, 0x05040100
    s_mov_b32 s99, 0x07060302
    v_lshl_or_b32 v23, v31, 16, v23
    v_lshl_or_b32 v35, v39, 16, v35
    v_lshl_or_b32 v46, v47, 16, v46
    v_lshl_or_b32 v92, v93, 16, v92
    v_perm_b32 v6, v64, v42, s98
    v_perm_b32 v64, v64, v42, s99
    v_perm_b32 v31, v65, v43, s98
    v_perm_b32 v65, v65, v43, s99
    v_perm_b32 v32, v66, v44, s98
    v_perm_b32 v66, v66, v44, s99
    v_perm_b32 v33, v67, v45, s98
    v_perm_b32 v67, v67, v45, s99
    v_perm_b32 v34, v72, v68, s98
    v_perm_b32 v72, v72, v68, s99
    v_perm_b32 v36, v73, v69, s98
    v_perm_b32 v73, v73, v69, s99
    v_perm_b32 v37, v74, v70, s98
    v_perm_b32 v74, v74, v70, s99
    v_perm_b32 v38, v75, v71, s98
    v_perm_b32 v75, v75, v71, s99
    v_perm_b32 v39, v80, v76, s98
    v_perm_b32 v80, v80, v76, s99
    v_perm_b32 v40, v81, v77, s98
    v_perm_b32 v81, v81, v77, s99
    v_perm_b32 v41, v82, v78, s98
    v_perm_b32 v82, v82, v78, s99
    v_perm_b32 v42, v83, v79, s98
    v_perm_b32 v83, v83, v79, s99
    v_perm_b32 v43, v88, v84, s98
    v_perm_b32 v88, v88, v84, s99
    v_perm_b32 v44, v89, v85, s98
    v_perm_b32 v89, v89, v85, s99
    v_perm_b32 v45, v90, v86, s98
    v_perm_b32 v90, v90, v86, s99
    v_perm_b32 v47, v91, v87, s98
    v_perm_b32 v91, v91, v87, s99
    s_mov_b32 s98, 0x05040100
    s_mov_b32 s99, 0x07060302
    v_mov_b32 v94, 0
    v_mov_b32 v95, 0
    v_mov_b32 v96, 0
    v_mov_b32 v97, 0
    v_mov_b32 v98, 0
    v_mov_b32 v99, 0
    v_mov_b32 v100, 0
    v_mov_b32 v101, 0
    v_mov_b32 v7, 0
    s_and_b32 s92, s4, 0xffff
    s_lshl_b32 s93, s4, 16
    s_lshr_b32 s94, s4, 16
    s_and_b32 s95, s4, 0xffff0000
    v_dot2c_f32_bf16_dpp v52, v15, v24 row_newbcast:11 row_mask:0xf bank_mask:0xf
    v_dot2c_f32_bf16_dpp v53, v16, v24 row_newbcast:11 row_mask:0xf bank_mask:0xf
    v_dot2c_f32_bf16_dpp v54, v15, v25 row_newbcast:11 row_mask:0xf bank_mask:0xf
    v_dot2c_f32_bf16_dpp v55, v16, v25 row_newbcast:11 row_mask:0xf bank_mask:0xf
    v_dot2c_f32_bf16_dpp v56, v15, v26 row_newbcast:11 row_mask:0xf bank_mask:0xf
    v_dot2c_f32_bf16_dpp v57, v16, v26 row_newbcast:11 row_mask:0xf bank_mask:0xf
    v_dot2c_f32_bf16_dpp v58, v15, v27 row_newbcast:11 row_mask:0xf bank_mask:0xf
    v_dot2c_f32_bf16_dpp v59, v16, v27 row_newbcast:11 row_mask:0xf bank_mask:0xf
    s_waitcnt vmcnt(1)
    v_dot2c_f32_bf16_dpp v52, v15, v48 row_newbcast:7 row_mask:0xf bank_mask:0xf
    v_dot2c_f32_bf16_dpp v53, v16, v48 row_newbcast:7 row_mask:0xf bank_mask:0xf
    v_dot2c_f32_bf16_dpp v54, v15, v49 row_newbcast:7 row_mask:0xf bank_mask:0xf
    v_dot2c_f32_bf16_dpp v55, v16, v49 row_newbcast:7 row_mask:0xf bank_mask:0xf
    v_dot2c_f32_bf16_dpp v56, v15, v50 row_newbcast:7 row_mask:0xf bank_mask:0xf
    v_dot2c_f32_bf16_dpp v57, v16, v50 row_newbcast:7 row_mask:0xf bank_mask:0xf
    v_dot2c_f32_bf16_dpp v58, v15, v51 row_newbcast:7 row_mask:0xf bank_mask:0xf
    v_dot2c_f32_bf16_dpp v59, v16, v51 row_newbcast:7 row_mask:0xf bank_mask:0xf
    s_waitcnt vmcnt(0)
    v_dot2c_f32_bf16_dpp v52, v15, v60 row_newbcast:15 row_mask:0xf bank_mask:0xf
    v_dot2c_f32_bf16_dpp v53, v16, v60 row_newbcast:15 row_mask:0xf bank_mask:0xf
    v_dot2c_f32_bf16_dpp v54, v15, v61 row_newbcast:15 row_mask:0xf bank_mask:0xf
    v_dot2c_f32_bf16_dpp v55, v16, v61 row_newbcast:15 row_mask:0xf bank_mask:0xf
    v_dot2c_f32_bf16_dpp v56, v15, v62 row_newbcast:15 row_mask:0xf bank_mask:0xf
    v_dot2c_f32_bf16_dpp v57, v16, v62 row_newbcast:15 row_mask:0xf bank_mask:0xf
    v_dot2c_f32_bf16_dpp v58, v15, v63 row_newbcast:15 row_mask:0xf bank_mask:0xf
    v_dot2c_f32_bf16_dpp v59, v16, v63 row_newbcast:15 row_mask:0xf bank_mask:0xf
    v_permlane32_swap_b32 v52, v56
    v_permlane32_swap_b32 v53, v57
    v_permlane32_swap_b32 v54, v58
    v_permlane32_swap_b32 v55, v59
    v_add_f32 v52, v52, v56
    v_add_f32 v53, v53, v57
    v_add_f32 v54, v54, v58
    v_add_f32 v55, v55, v59
    s_nop 0
    v_permlane16_swap_b32 v52, v54
    v_permlane16_swap_b32 v53, v55
    v_add_f32 v52, v52, v54
    v_add_f32 v53, v53, v55
    ds_write_b64 v9, v[52:53] offset:0
    s_cmp_gt_u32 s88, 3
    s_cbranch_scc1 L_w3_95
    s_mov_b32 s89, 36864
    buffer_load_dwordx4 v[24:27], v14, s[52:55], s89 offen offset:0
    buffer_load_ushort v8, v17, s[52:55], s89 offen offset:1024
L_w3_95:
    s_mov_b32 s89, 0
    buffer_load_dwordx4 v[48:51], v14, s[52:55], s89 offen offset:0
    buffer_load_ushort v15, v17, s[52:55], s89 offen offset:1024
    s_waitcnt lgkmcnt(0)
    s_barrier
    s_mov_b32 s89, 18432
    buffer_load_dwordx4 v[52:55], v14, s[52:55], s89 offen offset:0
    buffer_load_ushort v10, v17, s[52:55], s89 offen offset:1024
    ds_read_b64 v[102:103], v22 offset:0
    ds_read_b64 v[104:105], v22 offset:2112
    ds_read_b64 v[106:107], v22 offset:4224
    ds_read_b64 v[108:109], v22 offset:6336
    s_waitcnt lgkmcnt(2)
    v_add_f32 v102, v102, v104
    v_add_f32 v103, v103, v105
    s_waitcnt lgkmcnt(0)
    v_add_f32 v106, v106, v108
    v_add_f32 v107, v107, v109
    v_add_f32 v102, v102, v106
    v_add_f32 v103, v103, v107
    s_nop 0
    v_add_f32_dpp v102, v102, v102 quad_perm:[1,0,3,2] row_mask:0xf bank_mask:0xf
    v_add_f32_dpp v103, v103, v103 quad_perm:[1,0,3,2] row_mask:0xf bank_mask:0xf
    s_nop 0
    v_add_f32_dpp v102, v102, v102 quad_perm:[2,3,0,1] row_mask:0xf bank_mask:0xf
    v_add_f32_dpp v103, v103, v103 quad_perm:[2,3,0,1] row_mask:0xf bank_mask:0xf
    v_cvt_pk_bf16_f32 v16, v102, v103
    s_nop 1
    v_dot2c_f32_bf16_dpp v94, v16, v6 row_newbcast:0 row_mask:0xf bank_mask:0xf
    v_dot2c_f32_bf16_dpp v95, v16, v64 row_newbcast:0 row_mask:0xf bank_mask:0xf
    v_dot2c_f32_bf16_dpp v96, v16, v31 row_newbcast:0 row_mask:0xf bank_mask:0xf
    v_dot2c_f32_bf16_dpp v97, v16, v65 row_newbcast:0 row_mask:0xf bank_mask:0xf
    v_dot2c_f32_bf16_dpp v98, v16, v32 row_newbcast:0 row_mask:0xf bank_mask:0xf
    v_dot2c_f32_bf16_dpp v99, v16, v66 row_newbcast:0 row_mask:0xf bank_mask:0xf
    v_dot2c_f32_bf16_dpp v100, v16, v33 row_newbcast:0 row_mask:0xf bank_mask:0xf
    v_dot2c_f32_bf16_dpp v101, v16, v67 row_newbcast:0 row_mask:0xf bank_mask:0xf
    v_dot2c_f32_bf16_dpp v7, v16, v23 row_newbcast:0 row_mask:0xf bank_mask:0xf
    v_dot2c_f32_bf16_dpp v94, v16, v34 row_newbcast:4 row_mask:0xf bank_mask:0xf
    v_dot2c_f32_bf16_dpp v95, v16, v72 row_newbcast:4 row_mask:0xf bank_mask:0xf
    v_dot2c_f32_bf16_dpp v96, v16, v36 row_newbcast:4 row_mask:0xf bank_mask:0xf
    v_dot2c_f32_bf16_dpp v97, v16, v73 row_newbcast:4 row_mask:0xf bank_mask:0xf
    v_dot2c_f32_bf16_dpp v98, v16, v37 row_newbcast:4 row_mask:0xf bank_mask:0xf
    v_dot2c_f32_bf16_dpp v99, v16, v74 row_newbcast:4 row_mask:0xf bank_mask:0xf
    v_dot2c_f32_bf16_dpp v100, v16, v38 row_newbcast:4 row_mask:0xf bank_mask:0xf
    v_dot2c_f32_bf16_dpp v101, v16, v75 row_newbcast:4 row_mask:0xf bank_mask:0xf
    v_dot2c_f32_bf16_dpp v7, v16, v35 row_newbcast:4 row_mask:0xf bank_mask:0xf
    v_dot2c_f32_bf16_dpp v94, v16, v39 row_newbcast:8 row_mask:0xf bank_mask:0xf
    v_dot2c_f32_bf16_dpp v95, v16, v80 row_newbcast:8 row_mask:0xf bank_mask:0xf
    v_dot2c_f32_bf16_dpp v96, v16, v40 row_newbcast:8 row_mask:0xf bank_mask:0xf
    v_dot2c_f32_bf16_dpp v97, v16, v81 row_newbcast:8 row_mask:0xf bank_mask:0xf
    v_dot2c_f32_bf16_dpp v98, v16, v41 row_newbcast:8 row_mask:0xf bank_mask:0xf
    v_dot2c_f32_bf16_dpp v99, v16, v82 row_newbcast:8 row_mask:0xf bank_mask:0xf
    v_dot2c_f32_bf16_dpp v100, v16, v42 row_newbcast:8 row_mask:0xf bank_mask:0xf
    v_dot2c_f32_bf16_dpp v101, v16, v83 row_newbcast:8 row_mask:0xf bank_mask:0xf
    v_dot2c_f32_bf16_dpp v7, v16, v46 row_newbcast:8 row_mask:0xf bank_mask:0xf
    v_dot2c_f32_bf16_dpp v94, v16, v43 row_newbcast:12 row_mask:0xf bank_mask:0xf
    v_dot2c_f32_bf16_dpp v95, v16, v88 row_newbcast:12 row_mask:0xf bank_mask:0xf
    v_dot2c_f32_bf16_dpp v96, v16, v44 row_newbcast:12 row_mask:0xf bank_mask:0xf
    v_dot2c_f32_bf16_dpp v97, v16, v89 row_newbcast:12 row_mask:0xf bank_mask:0xf
    v_dot2c_f32_bf16_dpp v98, v16, v45 row_newbcast:12 row_mask:0xf bank_mask:0xf
    v_dot2c_f32_bf16_dpp v99, v16, v90 row_newbcast:12 row_mask:0xf bank_mask:0xf
    v_dot2c_f32_bf16_dpp v100, v16, v47 row_newbcast:12 row_mask:0xf bank_mask:0xf
    v_dot2c_f32_bf16_dpp v101, v16, v91 row_newbcast:12 row_mask:0xf bank_mask:0xf
    v_dot2c_f32_bf16_dpp v7, v16, v92 row_newbcast:12 row_mask:0xf bank_mask:0xf
    s_cmp_gt_u32 s88, 3
    s_cbranch_scc1 L_n3_96
    s_waitcnt vmcnt(4)
    s_lshl_b32 s3, s5, 16
    v_dot2c_f32_bf16 v7, s5, v8
    v_dot2c_f32_bf16 v94, s5, v24
    v_dot2c_f32_bf16 v95, s3, v24
    v_dot2c_f32_bf16 v96, s5, v25
    v_dot2c_f32_bf16 v97, s3, v25
    v_dot2c_f32_bf16 v98, s5, v26
    v_dot2c_f32_bf16 v99, s3, v26
    v_dot2c_f32_bf16 v100, s5, v27
    v_dot2c_f32_bf16 v101, s3, v27
L_n3_96:
    s_waitcnt vmcnt(2)
    v_dot2c_f32_bf16 v7, s92, v15
    v_dot2c_f32_bf16 v94, s92, v48
    v_dot2c_f32_bf16 v95, s93, v48
    v_dot2c_f32_bf16 v96, s92, v49
    v_dot2c_f32_bf16 v97, s93, v49
    v_dot2c_f32_bf16 v98, s92, v50
    v_dot2c_f32_bf16 v99, s93, v50
    v_dot2c_f32_bf16 v100, s92, v51
    v_dot2c_f32_bf16 v101, s93, v51
    s_waitcnt vmcnt(0)
    v_dot2c_f32_bf16 v7, s94, v10
    v_dot2c_f32_bf16 v94, s94, v52
    v_dot2c_f32_bf16 v95, s95, v52
    v_dot2c_f32_bf16 v96, s94, v53
    v_dot2c_f32_bf16 v97, s95, v53
    ds_write_b32 v12, v7 offset:11264
    v_dot2c_f32_bf16 v98, s94, v54
    v_dot2c_f32_bf16 v99, s95, v54
    v_dot2c_f32_bf16 v100, s94, v55
    v_dot2c_f32_bf16 v101, s95, v55
    ds_write_b128 v11, v[94:97] offset:9216
    s_nop 1
    ds_write_b128 v11, v[98:101] offset:10240
    s_cmp_gt_u32 s88, 8
    s_waitcnt lgkmcnt(0)
    s_barrier
    s_cbranch_scc1 L_pub_97
    ds_read_b128 v[32:35], v13 offset:9216
    ds_read_b128 v[36:39], v13 offset:18688
    ds_read_b128 v[40:43], v13 offset:28160
    ds_read_b128 v[44:47], v13 offset:37632
    s_waitcnt lgkmcnt(2)
    v_add_f32 v32, v32, v36
    v_add_f32 v33, v33, v37
    v_add_f32 v34, v34, v38
    v_add_f32 v35, v35, v39
    s_waitcnt lgkmcnt(0)
    v_add_f32 v40, v40, v44
    v_add_f32 v41, v41, v45
    v_add_f32 v42, v42, v46
    v_add_f32 v43, v43, v47
    v_add_f32 v32, v32, v40
    v_add_f32 v33, v33, v41
    v_add_f32 v34, v34, v42
    v_add_f32 v35, v35, v43
    v_add_f32_dpp v32, v32, v32 quad_perm:[1,0,3,2] row_mask:0xf bank_mask:0xf
    v_add_f32_dpp v33, v33, v33 quad_perm:[1,0,3,2] row_mask:0xf bank_mask:0xf
    v_add_f32_dpp v34, v34, v34 quad_perm:[1,0,3,2] row_mask:0xf bank_mask:0xf
    v_add_f32_dpp v35, v35, v35 quad_perm:[1,0,3,2] row_mask:0xf bank_mask:0xf
    v_add_f32_dpp v32, v32, v32 quad_perm:[2,3,0,1] row_mask:0xf bank_mask:0xf
    v_add_f32_dpp v33, v33, v33 quad_perm:[2,3,0,1] row_mask:0xf bank_mask:0xf
    v_add_f32_dpp v34, v34, v34 quad_perm:[2,3,0,1] row_mask:0xf bank_mask:0xf
    v_add_f32_dpp v35, v35, v35 quad_perm:[2,3,0,1] row_mask:0xf bank_mask:0xf
    v_and_or_b32 v32, v32, v30, s64
    v_and_or_b32 v33, v33, v30, s65
    v_and_or_b32 v34, v34, v30, s66
    v_and_or_b32 v35, v35, v30, s67
    buffer_store_dwordx4 v[32:35], v18, s[60:63], 0 offen sc1
L_pub_97:
    s_nop 4
    s_and_b32 s3, s2, 127
    s_cmp_ge_u32 s3, 18
    s_cbranch_scc1 L_fin
    s_mov_b32 s89, s7
    buffer_load_dwordx4 v[56:59], v19, s[80:83], s89 offen sc1
    s_mov_b32 s6, 200000
L_poll_98:
    s_waitcnt vmcnt(0)
    v_xor_b32 v56, s64, v56
    v_xor_b32 v57, s65, v57
    v_xor_b32 v58, s66, v58
    v_xor_b32 v59, s67, v59
    v_or3_b32 v6, v56, v57, v58
    v_or_b32 v6, v6, v59
    v_and_b32 v6, 0xff, v6
    v_cmp_ne_u32 vcc, 0, v6
    s_nop 1
    s_cmp_eq_u64 vcc, 0
    s_cbranch_scc1 L_pollok_99
    s_sub_u32 s6, s6, 1
    s_cbranch_scc1 L_pollok_99
    buffer_load_dwordx4 v[56:59], v19, s[80:83], s89 offen sc1
    s_branch L_poll_98
L_pollok_99:
    s_nop 1
    v_permlane32_swap_b32 v56, v58
    v_permlane32_swap_b32 v57, v59
    v_add_f32 v56, v56, v58
    v_add_f32 v57, v57, v59
    s_nop 1
    v_permlane16_swap_b32 v56, v57
    v_add_f32 v56, v56, v57
    s_nop 1
    v_add_f32_dpp v56, v56, v56 row_ror:8 row_mask:0xf bank_mask:0xf
    ds_write_b32 v20, v56 offset:0
    s_cmp_eq_u32 s88, 0
    s_waitcnt lgkmcnt(0)
    s_barrier
    s_cbranch_scc1 L_fin0_100
    s_cmp_lg_u32 s88, 1
    s_cbranch_scc1 L_fin
    s_cmp_lg_u32 s3, 0
    s_cbranch_scc1 L_fin
    s_lshl_b32 s3, s85, 7
    s_add_u32 s3, s3, 655360
    v_mov_b32 v20, s28
    v_mov_b32 v6, 0
    s_mov_b64 exec, 1
    buffer_store_dword v20, v6, s[80:83], s3 offen
    s_branch L_fin
L_fin0_100:
    ds_read2_b32 v[60:61], v29 offset0:0 offset1:32
    ds_read2_b32 v[62:63], v29 offset0:64 offset1:96
    ds_read2_b32 v[64:65], v29 offset0:128 offset1:160
    ds_read2_b32 v[66:67], v29 offset0:192 offset1:224
    s_mul_i32 s3, s85, 1152
    v_lshlrev_b32 v28, 16, v28
    v_mul_f32 v28, s97, v28
    s_waitcnt lgkmcnt(0)
    v_add_f32 v60, v60, v64
    v_add_f32 v61, v61, v65
    v_add_f32 v62, v62, v66
    v_add_f32 v63, v63, v67
    v_add_f32 v60, v60, v61
    v_add_f32 v62, v62, v63
    v_add_f32 v60, v60, v62
    v_mov_b32 v61, v60
    s_nop 1
    v_permlane32_swap_b32 v60, v61
    v_add_f32 v60, v60, v61
    v_fma_f32 v60, v60, s56, v28
    v_cvt_pk_bf16_f32 v60, v60, v60
    s_mov_b32 exec_hi, 0
    buffer_store_short v60, v21, s[76:79], s3 offen
L_fin:
L_end:
    s_endpgm
.section .rodata,"a"
.p2align 6
.amdhsa_kernel gated_mix__mha_block_cached__mixer_channel_mlp__decode_kernel
  .amdhsa_next_free_vgpr 128
  .amdhsa_next_free_sgpr 102
  .amdhsa_accum_offset 128
  .amdhsa_group_segment_fixed_size 0
  .amdhsa_kernarg_size 112
  .amdhsa_user_sgpr_count 2
  .amdhsa_user_sgpr_kernarg_segment_ptr 1
  .amdhsa_system_sgpr_workgroup_id_x 1
  .amdhsa_float_denorm_mode_32 3
.end_amdhsa_kernel
```
